```python
import torch

def _softmax(x, axis=-1):
    return torch.softmax(x, dim=axis)
def _gelu(x):
    return torch.nn.functional.gelu(x, approximate="tanh")
def _silu(x):
    return torch.nn.functional.silu(x)
def _sigmoid(x):
    return torch.sigmoid(x)
def _layernorm(x, axis=-1, eps=1e-5):
    m = x.mean(dim=axis, keepdim=True)
    v = x.var(dim=axis, keepdim=True, unbiased=False)
    return (x - m) / torch.sqrt(v + eps)
def _scatter_add(tgt, idx, src, axis=0):
    return tgt.clone().index_add_(axis, idx, src)
def _segment_sum(src, seg, n):
    out = torch.zeros((n,) + src.shape[1:], dtype=src.dtype)
    return out.index_add_(0, seg, src)
def _pad(x, pw):
    flat = tuple(v for pair in reversed(pw) for v in pair)
    return torch.nn.functional.pad(x, flat)

kernel_name = 'recurrent_scan__mha_block__dense_activation_squared_relu__prompt'

def setup_inputs():

    _w = (lambda a: (lambda t: t.to(torch.bfloat16) if t.is_floating_point() else t)(torch.as_tensor(a)))
    def _A_setup():
        B, S, D, H = 1, 2048, 512, 32
        return {
            "x": _w((lambda *s: torch.randn(*s, dtype=torch.bfloat16) * 0.05)(B, S, D)),
            "wqkv": _w((lambda *s: torch.randn(*s, dtype=torch.bfloat16) * 0.05)(D, 3 * D)),
            "wo": _w((lambda *s: torch.randn(*s, dtype=torch.bfloat16) * 0.05)(D, D)),
        }
    _A_in = _A_setup()

    def _B_setup():
        B, S, D, F = 1, 2048, 512, 1792
        return {
            "x": _w((lambda *s: torch.randn(*s, dtype=torch.bfloat16) * 0.05)(B, S, D)),
            "w1": _w((lambda *s: torch.randn(*s, dtype=torch.bfloat16) * 0.05)(D, F)),
            "b1": _w((lambda *s: torch.randn(*s, dtype=torch.bfloat16) * 0.4)(F)),
            "w2": _w((lambda *s: torch.randn(*s, dtype=torch.bfloat16) * 0.05)(F, D)),
            "b2": _w((lambda *s: torch.randn(*s, dtype=torch.bfloat16) * 1.6)(D)),
        }
    _B_in = _B_setup()

    return {
        "A_x": _A_in["x"],
        "A_wqkv": _A_in["wqkv"],
        "A_wo": _A_in["wo"],
        "B_x": _B_in["x"],
        "B_w1": _B_in["w1"],
        "B_b1": _B_in["b1"],
        "B_w2": _B_in["w2"],
        "B_b2": _B_in["b2"],
    }

def reference(A_x, A_wqkv, A_wo, B_x, B_w1, B_b1, B_w2, B_b2):
    def _A_ref(x, wqkv, wo):
        B, S, D = x.shape
        H = 32
        Dh = D // H
        qkv = (lambda x, *d: x.permute(*d))((x @ wqkv).reshape(B, S, 3, H, Dh), 2, 0, 3, 1, 4)
        q, k, v = qkv[0], qkv[1], qkv[2]
        scores = torch.einsum("bhqd,bhkd->bhqk", q, k) * (Dh ** -0.5)
        p = _softmax(scores, axis=-1)
        o = torch.einsum("bhqk,bhkd->bhqd", p, v)
        return (lambda x, *d: x.permute(*d))(o, 0, 2, 1, 3).reshape(B, S, D) @ wo

    def _B_ref(x, w1, b1, w2, b2):
        h = torch.einsum("bsd,df->bsf", x, w1) + b1
        zero = torch.zeros_like(h)
        r = torch.where(h > zero, h, zero)
        h = r * r
        out = torch.einsum("bsf,fd->bsd", h, w2) + b2
        return out

    x = A_x
    xn = _layernorm(x, axis=-1)
    s = _A_ref(xn, A_wqkv, A_wo)
    g = _silu(_B_ref(xn, B_w1, B_b1, B_w2, B_b2))
    return x + s * g
```

```asm
; @launch kernel=k1_kernel grid=(256,1,1) block=(1024,1,1) lds=135168
; @launch kernel=k2_kernel grid=(256,1,1) block=(768,1,1) lds=163840
.amdgcn_target "amdgcn-amd-amdhsa--gfx950"
.text
.globl k1_kernel
.p2align 8
.type k1_kernel,@function
k1_kernel:
  s_cmp_ge_u32 s2, 256
  s_cbranch_scc1 k1_kernel_exit
  s_load_dwordx2 s[8:9], s[0:1], 0
  s_load_dwordx2 s[12:13], s[0:1], 8
  s_load_dwordx2 s[16:17], s[0:1], 80
  v_lshrrev_b32 v4, 6, v0
  v_and_b32 v1, 63, v0
  v_readfirstlane_b32 s22, v4
  s_and_b32 s44, s2, 3
  s_lshl_b32 s44, s44, 3
  s_lshr_b32 s45, s2, 3
  s_and_b32 s46, s45, 7
  s_add_u32 s20, s44, s46
  s_lshr_b32 s44, s2, 2
  s_and_b32 s44, s44, 1
  s_lshl_b32 s44, s44, 2
  s_lshr_b32 s45, s45, 3
  s_add_u32 s21, s44, s45
  s_and_b32 s23, s22, 1
  s_bfe_u32 s27, s22, 0x10001
  s_lshl_b32 s24, s20, 1
  s_add_u32 s24, s24, s23
  s_cmp_ge_u32 s22, 12
  s_cbranch_scc0 k1_kernel_cmp
  s_and_b32 s35, s22, 3
  v_lshrrev_b32 v7, 3, v1
  v_and_b32 v8, 7, v1
  v_lshrrev_b32 v9, 1, v7
  v_xor_b32 v10, v9, v8
  v_lshlrev_b32 v10, 4, v10
  v_lshl_add_u32 v4, v7, 10, v10
  v_xor_b32 v5, 64, v4
  v_and_b32 v9, 1, v9
  v_lshlrev_b32 v9, 2, v9
  v_xor_b32 v9, v9, v8
  v_lshlrev_b32 v9, 4, v9
  v_mul_u32_u24 v7, 3072, v7
  v_add_u32 v6, v7, v9
  s_lshl_b32 s31, s20, 16
  s_lshl_b32 s32, s35, 14
  s_add_u32 s31, s31, s32
  s_mul_i32 s32, s35, 49152
  s_lshl_b32 s33, s21, 7
  s_add_u32 s32, s32, s33
  s_lshl_b32 s33, s35, 11
  s_waitcnt lgkmcnt(0)
  s_mov_b32 s28, 0xffff0000
  s_mov_b32 s29, 0x3f803f80
  s_mov_b32 s10, 2097152
  s_mov_b32 s11, 0x20000
  s_mov_b32 s14, 1572864
  s_mov_b32 s15, 0x20000
  s_mov_b32 s18, 21495808
  s_mov_b32 s19, 0x20000
  s_setprio 3
  s_add_u32 s36, s33, 0
  s_add_u32 m0, s36, 8192
  s_add_u32 s37, s32, 0
  buffer_load_dwordx4 v6, s[12:15], s37 offen lds
  s_add_u32 m0, s36, 9216
  s_add_u32 s37, s32, 24576
  buffer_load_dwordx4 v6, s[12:15], s37 offen lds
  s_add_u32 m0, s36, 16384
  s_add_u32 s37, s32, 1024
  buffer_load_dwordx4 v6, s[12:15], s37 offen lds
  s_add_u32 m0, s36, 17408
  s_add_u32 s37, s32, 25600
  buffer_load_dwordx4 v6, s[12:15], s37 offen lds
  s_add_u32 m0, s36, 24576
  s_add_u32 s37, s32, 2048
  buffer_load_dwordx4 v6, s[12:15], s37 offen lds
  s_add_u32 m0, s36, 25600
  s_add_u32 s37, s32, 26624
  buffer_load_dwordx4 v6, s[12:15], s37 offen lds
  s_add_u32 m0, s36, 0
  s_add_u32 s37, s31, 0
  buffer_load_dwordx4 v4, s[8:11], s37 offen lds
  s_add_u32 m0, s36, 1024
  s_add_u32 s37, s31, 8192
  buffer_load_dwordx4 v5, s[8:11], s37 offen lds
  s_add_u32 s31, s31, 128
  s_add_u32 s32, s32, 196608
  s_add_u32 s36, s33, 32768
  s_add_u32 m0, s36, 8192
  s_add_u32 s37, s32, 0
  buffer_load_dwordx4 v6, s[12:15], s37 offen lds
  s_add_u32 m0, s36, 9216
  s_add_u32 s37, s32, 24576
  buffer_load_dwordx4 v6, s[12:15], s37 offen lds
  s_add_u32 m0, s36, 16384
  s_add_u32 s37, s32, 1024
  buffer_load_dwordx4 v6, s[12:15], s37 offen lds
  s_add_u32 m0, s36, 17408
  s_add_u32 s37, s32, 25600
  buffer_load_dwordx4 v6, s[12:15], s37 offen lds
  s_add_u32 m0, s36, 24576
  s_add_u32 s37, s32, 2048
  buffer_load_dwordx4 v6, s[12:15], s37 offen lds
  s_add_u32 m0, s36, 25600
  s_add_u32 s37, s32, 26624
  buffer_load_dwordx4 v6, s[12:15], s37 offen lds
  s_add_u32 m0, s36, 0
  s_add_u32 s37, s31, 0
  buffer_load_dwordx4 v4, s[8:11], s37 offen lds
  s_add_u32 m0, s36, 1024
  s_add_u32 s37, s31, 8192
  buffer_load_dwordx4 v5, s[8:11], s37 offen lds
  s_add_u32 s31, s31, 128
  s_add_u32 s32, s32, 196608
  s_waitcnt vmcnt(8)
  s_barrier
  s_add_u32 s36, s33, 65536
  s_add_u32 m0, s36, 8192
  s_add_u32 s37, s32, 0
  buffer_load_dwordx4 v6, s[12:15], s37 offen lds
  s_add_u32 m0, s36, 9216
  s_add_u32 s37, s32, 24576
  buffer_load_dwordx4 v6, s[12:15], s37 offen lds
  s_add_u32 m0, s36, 16384
  s_add_u32 s37, s32, 1024
  buffer_load_dwordx4 v6, s[12:15], s37 offen lds
  s_add_u32 m0, s36, 17408
  s_add_u32 s37, s32, 25600
  buffer_load_dwordx4 v6, s[12:15], s37 offen lds
  s_add_u32 m0, s36, 24576
  s_add_u32 s37, s32, 2048
  buffer_load_dwordx4 v6, s[12:15], s37 offen lds
  s_add_u32 m0, s36, 25600
  s_add_u32 s37, s32, 26624
  buffer_load_dwordx4 v6, s[12:15], s37 offen lds
  s_add_u32 m0, s36, 0
  s_add_u32 s37, s31, 0
  buffer_load_dwordx4 v4, s[8:11], s37 offen lds
  s_add_u32 m0, s36, 1024
  s_add_u32 s37, s31, 8192
  buffer_load_dwordx4 v5, s[8:11], s37 offen lds
  s_add_u32 s31, s31, 128
  s_add_u32 s32, s32, 196608
  s_add_u32 s36, s33, 98304
  s_add_u32 m0, s36, 8192
  s_add_u32 s37, s32, 0
  buffer_load_dwordx4 v6, s[12:15], s37 offen lds
  s_add_u32 m0, s36, 9216
  s_add_u32 s37, s32, 24576
  buffer_load_dwordx4 v6, s[12:15], s37 offen lds
  s_add_u32 m0, s36, 16384
  s_add_u32 s37, s32, 1024
  buffer_load_dwordx4 v6, s[12:15], s37 offen lds
  s_add_u32 m0, s36, 17408
  s_add_u32 s37, s32, 25600
  buffer_load_dwordx4 v6, s[12:15], s37 offen lds
  s_add_u32 m0, s36, 24576
  s_add_u32 s37, s32, 2048
  buffer_load_dwordx4 v6, s[12:15], s37 offen lds
  s_add_u32 m0, s36, 25600
  s_add_u32 s37, s32, 26624
  buffer_load_dwordx4 v6, s[12:15], s37 offen lds
  s_add_u32 m0, s36, 0
  s_add_u32 s37, s31, 0
  buffer_load_dwordx4 v4, s[8:11], s37 offen lds
  s_add_u32 m0, s36, 1024
  s_add_u32 s37, s31, 8192
  buffer_load_dwordx4 v5, s[8:11], s37 offen lds
  s_add_u32 s31, s31, 128
  s_add_u32 s32, s32, 196608
  s_cmp_lg_u32 s35, 0
  s_cbranch_scc1 k1_kernel_nz
  v_mov_b32 v12, 0
  v_mov_b32 v13, 0
  v_mov_b32 v14, 0
  v_mov_b32 v15, 0
  v_lshlrev_b32 v16, 4, v1
  s_lshl_b32 s39, s2, 11
  s_add_u32 s39, s39, 20971520
  buffer_store_dwordx4 v[12:15], v16, s[16:19], s39 offen offset:0
  buffer_store_dwordx4 v[12:15], v16, s[16:19], s39 offen offset:1024
  s_waitcnt vmcnt(0)
k1_kernel_nz:
  s_waitcnt vmcnt(16)
  s_barrier
  s_waitcnt vmcnt(8)
  s_barrier
  s_add_u32 s36, s33, 0
  s_add_u32 m0, s36, 8192
  s_add_u32 s37, s32, 0
  buffer_load_dwordx4 v6, s[12:15], s37 offen lds
  s_add_u32 m0, s36, 9216
  s_add_u32 s37, s32, 24576
  buffer_load_dwordx4 v6, s[12:15], s37 offen lds
  s_add_u32 m0, s36, 16384
  s_add_u32 s37, s32, 1024
  buffer_load_dwordx4 v6, s[12:15], s37 offen lds
  s_add_u32 m0, s36, 17408
  s_add_u32 s37, s32, 25600
  buffer_load_dwordx4 v6, s[12:15], s37 offen lds
  s_add_u32 m0, s36, 24576
  s_add_u32 s37, s32, 2048
  buffer_load_dwordx4 v6, s[12:15], s37 offen lds
  s_add_u32 m0, s36, 25600
  s_add_u32 s37, s32, 26624
  buffer_load_dwordx4 v6, s[12:15], s37 offen lds
  s_add_u32 m0, s36, 0
  s_add_u32 s37, s31, 0
  buffer_load_dwordx4 v4, s[8:11], s37 offen lds
  s_add_u32 m0, s36, 1024
  s_add_u32 s37, s31, 8192
  buffer_load_dwordx4 v5, s[8:11], s37 offen lds
  s_add_u32 s31, s31, 128
  s_add_u32 s32, s32, 196608
  s_waitcnt vmcnt(8)
  s_barrier
  s_add_u32 s36, s33, 32768
  s_add_u32 m0, s36, 8192
  s_add_u32 s37, s32, 0
  buffer_load_dwordx4 v6, s[12:15], s37 offen lds
  s_add_u32 m0, s36, 9216
  s_add_u32 s37, s32, 24576
  buffer_load_dwordx4 v6, s[12:15], s37 offen lds
  s_add_u32 m0, s36, 16384
  s_add_u32 s37, s32, 1024
  buffer_load_dwordx4 v6, s[12:15], s37 offen lds
  s_add_u32 m0, s36, 17408
  s_add_u32 s37, s32, 25600
  buffer_load_dwordx4 v6, s[12:15], s37 offen lds
  s_add_u32 m0, s36, 24576
  s_add_u32 s37, s32, 2048
  buffer_load_dwordx4 v6, s[12:15], s37 offen lds
  s_add_u32 m0, s36, 25600
  s_add_u32 s37, s32, 26624
  buffer_load_dwordx4 v6, s[12:15], s37 offen lds
  s_add_u32 m0, s36, 0
  s_add_u32 s37, s31, 0
  buffer_load_dwordx4 v4, s[8:11], s37 offen lds
  s_add_u32 m0, s36, 1024
  s_add_u32 s37, s31, 8192
  buffer_load_dwordx4 v5, s[8:11], s37 offen lds
  s_add_u32 s31, s31, 128
  s_add_u32 s32, s32, 196608
  s_waitcnt vmcnt(8)
  s_barrier
  s_add_u32 s36, s33, 65536
  s_add_u32 m0, s36, 8192
  s_add_u32 s37, s32, 0
  buffer_load_dwordx4 v6, s[12:15], s37 offen lds
  s_add_u32 m0, s36, 9216
  s_add_u32 s37, s32, 24576
  buffer_load_dwordx4 v6, s[12:15], s37 offen lds
  s_add_u32 m0, s36, 16384
  s_add_u32 s37, s32, 1024
  buffer_load_dwordx4 v6, s[12:15], s37 offen lds
  s_add_u32 m0, s36, 17408
  s_add_u32 s37, s32, 25600
  buffer_load_dwordx4 v6, s[12:15], s37 offen lds
  s_add_u32 m0, s36, 24576
  s_add_u32 s37, s32, 2048
  buffer_load_dwordx4 v6, s[12:15], s37 offen lds
  s_add_u32 m0, s36, 25600
  s_add_u32 s37, s32, 26624
  buffer_load_dwordx4 v6, s[12:15], s37 offen lds
  s_add_u32 m0, s36, 0
  s_add_u32 s37, s31, 0
  buffer_load_dwordx4 v4, s[8:11], s37 offen lds
  s_add_u32 m0, s36, 1024
  s_add_u32 s37, s31, 8192
  buffer_load_dwordx4 v5, s[8:11], s37 offen lds
  s_add_u32 s31, s31, 128
  s_add_u32 s32, s32, 196608
  s_waitcnt vmcnt(8)
  s_barrier
  s_add_u32 s36, s33, 98304
  s_add_u32 m0, s36, 8192
  s_add_u32 s37, s32, 0
  buffer_load_dwordx4 v6, s[12:15], s37 offen lds
  s_add_u32 m0, s36, 9216
  s_add_u32 s37, s32, 24576
  buffer_load_dwordx4 v6, s[12:15], s37 offen lds
  s_add_u32 m0, s36, 16384
  s_add_u32 s37, s32, 1024
  buffer_load_dwordx4 v6, s[12:15], s37 offen lds
  s_add_u32 m0, s36, 17408
  s_add_u32 s37, s32, 25600
  buffer_load_dwordx4 v6, s[12:15], s37 offen lds
  s_add_u32 m0, s36, 24576
  s_add_u32 s37, s32, 2048
  buffer_load_dwordx4 v6, s[12:15], s37 offen lds
  s_add_u32 m0, s36, 25600
  s_add_u32 s37, s32, 26624
  buffer_load_dwordx4 v6, s[12:15], s37 offen lds
  s_add_u32 m0, s36, 0
  s_add_u32 s37, s31, 0
  buffer_load_dwordx4 v4, s[8:11], s37 offen lds
  s_add_u32 m0, s36, 1024
  s_add_u32 s37, s31, 8192
  buffer_load_dwordx4 v5, s[8:11], s37 offen lds
  s_add_u32 s31, s31, 128
  s_add_u32 s32, s32, 196608
  s_waitcnt vmcnt(8)
  s_barrier
  s_waitcnt vmcnt(0)
  s_barrier
  s_endpgm
k1_kernel_cmp:
  s_waitcnt lgkmcnt(0)
  s_mov_b32 s28, 0xffff0000
  s_mov_b32 s29, 0x3f803f80
  s_mov_b32 s10, 2097152
  s_mov_b32 s11, 0x20000
  s_mov_b32 s14, 1572864
  s_mov_b32 s15, 0x20000
  s_mov_b32 s18, 21495808
  s_mov_b32 s19, 0x20000
  s_cmp_ge_u32 s22, 4
  s_cbranch_scc1 k1_kernel_pf
  s_lshl_b32 s46, s2, 2
  s_add_u32 s46, s46, s22
  v_lshlrev_b32 v20, 10, v1
  v_add_u32 v20, s46, v20
  v_lshlrev_b32 v20, 7, v20
  buffer_load_dword v127, v20, s[8:11], 0 offen
  buffer_load_dword v127, v20, s[12:15], 0 offen
k1_kernel_pf:
  s_cmp_ge_u32 s22, 8
  s_cbranch_scc1 k1_kernel_st
  s_cmp_ge_u32 s22, 4
  s_cbranch_scc1 k1_kernel_r1
  s_xor_b32 s40, s23, 0
  s_lshl_b32 s44, s40, 11
  s_lshl_b32 s40, s40, 5
  s_xor_b32 s41, s23, 1
  s_lshl_b32 s45, s41, 11
  s_lshl_b32 s41, s41, 5
  s_xor_b32 s42, s23, 2
  s_lshl_b32 s46, s42, 11
  s_lshl_b32 s42, s42, 5
  s_xor_b32 s43, s23, 3
  s_lshl_b32 s47, s43, 11
  s_lshl_b32 s43, s43, 5
  v_and_b32 v4, 31, v1
  v_lshrrev_b32 v5, 5, v1
  v_bfe_u32 v6, v1, 1, 3
  v_xor_b32 v6, v6, v5
  v_lshlrev_b32 v6, 4, v6
  v_lshl_add_u32 v6, v4, 7, v6
  s_lshl_b32 s30, s23, 12
  v_add_u32 v6, s30, v6
  v_xor_b32 v108, s40, v6
  v_xor_b32 v109, s41, v6
  v_xor_b32 v110, s42, v6
  v_xor_b32 v111, s43, v6
  v_lshlrev_b32 v6, 3, v5
  v_bfe_u32 v7, v1, 2, 2
  v_add_u32 v6, v6, v7
  v_lshlrev_b32 v6, 7, v6
  v_lshrrev_b32 v7, 1, v7
  v_xor_b32 v7, s27, v7
  v_lshl_add_u32 v6, v7, 6, v6
  v_bfe_u32 v7, v1, 4, 1
  v_lshl_add_u32 v6, v7, 5, v6
  v_and_b32 v7, 3, v1
  v_lshl_add_u32 v6, v7, 3, v6
  v_add_u32 v112, s44, v6
  v_add_u32 v113, s45, v6
  v_add_u32 v114, s46, v6
  v_add_u32 v115, s47, v6
  v_mov_b32 v100, v108
  v_mov_b32 v101, v109
  v_mov_b32 v102, v110
  v_mov_b32 v103, v111
  v_mov_b32 v104, v112
  v_mov_b32 v105, v113
  v_mov_b32 v106, v114
  v_mov_b32 v107, v115
  v_mov_b32 v16, 0
  v_mov_b32 v17, 0
  v_mov_b32 v18, 0
  v_mov_b32 v19, 0
  v_mov_b32 v20, 0
  v_mov_b32 v21, 0
  v_mov_b32 v22, 0
  v_mov_b32 v23, 0
  v_mov_b32 v24, 0
  v_mov_b32 v25, 0
  v_mov_b32 v26, 0
  v_mov_b32 v27, 0
  v_mov_b32 v28, 0
  v_mov_b32 v29, 0
  v_mov_b32 v30, 0
  v_mov_b32 v31, 0
  v_mov_b32 v32, 0
  v_mov_b32 v33, 0
  v_mov_b32 v34, 0
  v_mov_b32 v35, 0
  v_mov_b32 v36, 0
  v_mov_b32 v37, 0
  v_mov_b32 v38, 0
  v_mov_b32 v39, 0
  v_mov_b32 v40, 0
  v_mov_b32 v41, 0
  v_mov_b32 v42, 0
  v_mov_b32 v43, 0
  v_mov_b32 v44, 0
  v_mov_b32 v45, 0
  v_mov_b32 v46, 0
  v_mov_b32 v47, 0
  v_mov_b32 v116, 0
  v_mov_b32 v117, 0
  v_mov_b32 v118, 0
  v_mov_b32 v119, 0
  v_mov_b32 v120, 0
  v_mov_b32 v121, 0
  v_mov_b32 v122, 0
  v_mov_b32 v123, 0
  s_mov_b32 s26, 0
  s_mov_b32 s25, 0
  s_barrier
  ds_read_b128 v[56:59], v100
  ds_read_b64_tr_b16 v[48:49], v104 offset:8192
  ds_read_b64_tr_b16 v[50:51], v104 offset:8704
  ds_read_b64_tr_b16 v[52:53], v104 offset:16384
  ds_read_b64_tr_b16 v[54:55], v104 offset:16896
  ds_read_b128 v[68:71], v101
  ds_read_b64_tr_b16 v[60:61], v105 offset:8192
  ds_read_b64_tr_b16 v[62:63], v105 offset:8704
  ds_read_b64_tr_b16 v[64:65], v105 offset:16384
  ds_read_b64_tr_b16 v[66:67], v105 offset:16896
k1_kernel_r0_loop:
  s_waitcnt lgkmcnt(5)
  v_mfma_f32_32x32x16_bf16 v[16:31], v[48:51], v[56:59], v[16:31]
  ds_read_b128 v[80:83], v102
  ds_read_b64_tr_b16 v[72:73], v106 offset:8192
  ds_read_b64_tr_b16 v[74:75], v106 offset:8704
  v_mfma_f32_32x32x16_bf16 v[32:47], v[52:55], v[56:59], v[32:47]
  ds_read_b64_tr_b16 v[76:77], v106 offset:16384
  ds_read_b64_tr_b16 v[78:79], v106 offset:16896
  v_dot2c_f32_bf16 v116, s29, v48
  v_dot2c_f32_bf16 v117, s29, v49
  v_dot2c_f32_bf16 v118, s29, v50
  v_dot2c_f32_bf16 v119, s29, v51
  v_dot2c_f32_bf16 v120, s29, v52
  v_dot2c_f32_bf16 v121, s29, v53
  v_dot2c_f32_bf16 v122, s29, v54
  v_dot2c_f32_bf16 v123, s29, v55
  s_waitcnt lgkmcnt(5)
  v_mfma_f32_32x32x16_bf16 v[16:31], v[60:63], v[68:71], v[16:31]
  ds_read_b128 v[92:95], v103
  ds_read_b64_tr_b16 v[84:85], v107 offset:8192
  ds_read_b64_tr_b16 v[86:87], v107 offset:8704
  v_mfma_f32_32x32x16_bf16 v[32:47], v[64:67], v[68:71], v[32:47]
  ds_read_b64_tr_b16 v[88:89], v107 offset:16384
  ds_read_b64_tr_b16 v[90:91], v107 offset:16896
  s_waitcnt lgkmcnt(5)
  s_cmp_ge_u32 s25, 7
  s_cbranch_scc1 L_nb_1
  s_barrier
L_nb_1:
  s_add_u32 s26, s26, 32768
  s_and_b32 s26, s26, 131071
  v_add_u32 v100, s26, v108
  v_add_u32 v101, s26, v109
  v_add_u32 v104, s26, v112
  v_add_u32 v105, s26, v113
  v_mfma_f32_32x32x16_bf16 v[16:31], v[72:75], v[80:83], v[16:31]
  ds_read_b128 v[56:59], v100
  ds_read_b64_tr_b16 v[48:49], v104 offset:8192
  ds_read_b64_tr_b16 v[50:51], v104 offset:8704
  v_mfma_f32_32x32x16_bf16 v[32:47], v[76:79], v[80:83], v[32:47]
  ds_read_b64_tr_b16 v[52:53], v104 offset:16384
  ds_read_b64_tr_b16 v[54:55], v104 offset:16896
  v_dot2c_f32_bf16 v116, s29, v72
  v_dot2c_f32_bf16 v117, s29, v73
  v_dot2c_f32_bf16 v118, s29, v74
  v_dot2c_f32_bf16 v119, s29, v75
  v_dot2c_f32_bf16 v120, s29, v76
  v_dot2c_f32_bf16 v121, s29, v77
  v_dot2c_f32_bf16 v122, s29, v78
  v_dot2c_f32_bf16 v123, s29, v79
  s_waitcnt lgkmcnt(5)
  v_mfma_f32_32x32x16_bf16 v[16:31], v[84:87], v[92:95], v[16:31]
  ds_read_b128 v[68:71], v101
  ds_read_b64_tr_b16 v[60:61], v105 offset:8192
  ds_read_b64_tr_b16 v[62:63], v105 offset:8704
  v_mfma_f32_32x32x16_bf16 v[32:47], v[88:91], v[92:95], v[32:47]
  ds_read_b64_tr_b16 v[64:65], v105 offset:16384
  ds_read_b64_tr_b16 v[66:67], v105 offset:16896
  v_add_u32 v102, s26, v110
  v_add_u32 v103, s26, v111
  v_add_u32 v106, s26, v114
  v_add_u32 v107, s26, v115
  s_add_u32 s25, s25, 1
  s_cmp_lt_u32 s25, 8
  s_cbranch_scc1 k1_kernel_r0_loop
  v_add_f32 v116, v116, v117
  v_add_f32 v118, v118, v119
  v_add_f32 v120, v120, v121
  v_add_f32 v122, v122, v123
  v_add_f32 v96, v116, v118
  v_add_f32 v97, v120, v122
  s_waitcnt lgkmcnt(0)
  v_mov_b32 v4, v96
  v_mov_b32 v5, v97
  v_and_b32 v10, 31, v1
  s_mul_i32 s30, s23, 768
  s_lshl_b32 s31, s27, 7
  s_add_u32 s30, s30, s31
  s_add_u32 s30, s30, 131072
  v_permlane32_swap_b32 v96, v4
  v_permlane32_swap_b32 v97, v5
  v_lshl_add_u32 v11, v10, 2, s30
  v_add_f32 v96, v96, v4
  v_add_f32 v97, v97, v5
  ds_write_b32 v11, v96 offset:0
  ds_write_b32 v11, v97 offset:256
  s_add_u32 s31, s31, 131072
  v_lshl_add_u32 v11, v10, 2, s31
  s_lshl_b32 s30, s23, 7
  s_add_u32 s30, s30, 132608
  v_lshl_add_u32 v12, v10, 2, s30
  v_lshlrev_b32 v13, 4, v1
  s_waitcnt lgkmcnt(0)
  s_barrier
  ds_read_b32 v48, v11 offset:0
  ds_read_b32 v49, v11 offset:768
  ds_read_b32 v52, v11 offset:256
  ds_read_b32 v53, v11 offset:1024
  s_barrier
  ds_read_b32 v98, v12
  ds_read_b32 v99, v12 offset:256
  s_lshl_b32 s30, s22, 8
  s_add_u32 s30, s30, 134144
  v_lshl_add_u32 v11, v10, 2, s30
  v_lshrrev_b32 v12, 5, v1
  v_lshlrev_b32 v12, 4, v12
  v_add_u32 v12, s30, v12
  s_waitcnt lgkmcnt(2)
  v_add_f32 v96, v48, v49
  v_add_f32 v97, v52, v53
  ds_write_b32 v11, v96 offset:0
  ds_write_b32 v11, v97 offset:128
  s_waitcnt lgkmcnt(0)
  ds_read_b128 v[48:51], v12 offset:0
  ds_read_b128 v[52:55], v12 offset:32
  ds_read_b128 v[56:59], v12 offset:64
  ds_read_b128 v[60:63], v12 offset:96
  ds_read_b128 v[64:67], v12 offset:128
  ds_read_b128 v[68:71], v12 offset:160
  ds_read_b128 v[72:75], v12 offset:192
  ds_read_b128 v[76:79], v12 offset:224
  v_mul_f32 v4, 0x3eb8aa3b, v98
  v_mul_f32 v5, 0x3eb8aa3b, v99
  s_lshl_b32 s30, s21, 1
  s_add_u32 s30, s30, s27
  s_lshl_b32 s30, s30, 17
  s_lshl_b32 s31, s24, 10
  s_add_u32 s30, s30, s31
  s_waitcnt lgkmcnt(4)
  v_pk_mul_f32 v[48:49], v[48:49], v[4:5] op_sel:[0,1] op_sel_hi:[1,1]
  v_pk_mul_f32 v[50:51], v[50:51], v[4:5] op_sel:[0,1] op_sel_hi:[1,1]
  v_pk_mul_f32 v[52:53], v[52:53], v[4:5] op_sel:[0,1] op_sel_hi:[1,1]
  v_pk_mul_f32 v[54:55], v[54:55], v[4:5] op_sel:[0,1] op_sel_hi:[1,1]
  v_pk_mul_f32 v[56:57], v[56:57], v[4:5] op_sel:[0,1] op_sel_hi:[1,1]
  v_pk_mul_f32 v[58:59], v[58:59], v[4:5] op_sel:[0,1] op_sel_hi:[1,1]
  v_pk_mul_f32 v[60:61], v[60:61], v[4:5] op_sel:[0,1] op_sel_hi:[1,1]
  v_pk_mul_f32 v[62:63], v[62:63], v[4:5] op_sel:[0,1] op_sel_hi:[1,1]
  v_pk_fma_f32 v[16:17], v[16:17], v[4:5], v[48:49] op_sel_hi:[1,0,1] neg_lo:[0,0,1] neg_hi:[0,0,1]
  v_pk_fma_f32 v[18:19], v[18:19], v[4:5], v[50:51] op_sel_hi:[1,0,1] neg_lo:[0,0,1] neg_hi:[0,0,1]
  v_pk_fma_f32 v[20:21], v[20:21], v[4:5], v[52:53] op_sel_hi:[1,0,1] neg_lo:[0,0,1] neg_hi:[0,0,1]
  v_pk_fma_f32 v[22:23], v[22:23], v[4:5], v[54:55] op_sel_hi:[1,0,1] neg_lo:[0,0,1] neg_hi:[0,0,1]
  v_pk_fma_f32 v[24:25], v[24:25], v[4:5], v[56:57] op_sel_hi:[1,0,1] neg_lo:[0,0,1] neg_hi:[0,0,1]
  v_pk_fma_f32 v[26:27], v[26:27], v[4:5], v[58:59] op_sel_hi:[1,0,1] neg_lo:[0,0,1] neg_hi:[0,0,1]
  v_pk_fma_f32 v[28:29], v[28:29], v[4:5], v[60:61] op_sel_hi:[1,0,1] neg_lo:[0,0,1] neg_hi:[0,0,1]
  v_pk_fma_f32 v[30:31], v[30:31], v[4:5], v[62:63] op_sel_hi:[1,0,1] neg_lo:[0,0,1] neg_hi:[0,0,1]
  v_cvt_pk_bf16_f32 v48, v16, v17
  v_cvt_pk_bf16_f32 v49, v18, v19
  v_cvt_pk_bf16_f32 v50, v20, v21
  v_cvt_pk_bf16_f32 v51, v22, v23
  v_cvt_pk_bf16_f32 v52, v24, v25
  v_cvt_pk_bf16_f32 v53, v26, v27
  v_cvt_pk_bf16_f32 v54, v28, v29
  v_cvt_pk_bf16_f32 v55, v30, v31
  buffer_store_dwordx4 v[48:51], v13, s[16:19], s30 offen sc1
  s_add_u32 s30, s30, 65536
  buffer_store_dwordx4 v[52:55], v13, s[16:19], s30 offen sc1
  s_waitcnt lgkmcnt(0)
  v_pk_mul_f32 v[64:65], v[64:65], v[98:99] op_sel:[0,1] op_sel_hi:[1,1]
  v_pk_mul_f32 v[66:67], v[66:67], v[98:99] op_sel:[0,1] op_sel_hi:[1,1]
  v_pk_mul_f32 v[68:69], v[68:69], v[98:99] op_sel:[0,1] op_sel_hi:[1,1]
  v_pk_mul_f32 v[70:71], v[70:71], v[98:99] op_sel:[0,1] op_sel_hi:[1,1]
  v_pk_mul_f32 v[72:73], v[72:73], v[98:99] op_sel:[0,1] op_sel_hi:[1,1]
  v_pk_mul_f32 v[74:75], v[74:75], v[98:99] op_sel:[0,1] op_sel_hi:[1,1]
  v_pk_mul_f32 v[76:77], v[76:77], v[98:99] op_sel:[0,1] op_sel_hi:[1,1]
  v_pk_mul_f32 v[78:79], v[78:79], v[98:99] op_sel:[0,1] op_sel_hi:[1,1]
  v_pk_fma_f32 v[32:33], v[32:33], v[98:99], v[64:65] op_sel_hi:[1,0,1] neg_lo:[0,0,1] neg_hi:[0,0,1]
  v_pk_fma_f32 v[34:35], v[34:35], v[98:99], v[66:67] op_sel_hi:[1,0,1] neg_lo:[0,0,1] neg_hi:[0,0,1]
  v_pk_fma_f32 v[36:37], v[36:37], v[98:99], v[68:69] op_sel_hi:[1,0,1] neg_lo:[0,0,1] neg_hi:[0,0,1]
  v_pk_fma_f32 v[38:39], v[38:39], v[98:99], v[70:71] op_sel_hi:[1,0,1] neg_lo:[0,0,1] neg_hi:[0,0,1]
  v_pk_fma_f32 v[40:41], v[40:41], v[98:99], v[72:73] op_sel_hi:[1,0,1] neg_lo:[0,0,1] neg_hi:[0,0,1]
  v_pk_fma_f32 v[42:43], v[42:43], v[98:99], v[74:75] op_sel_hi:[1,0,1] neg_lo:[0,0,1] neg_hi:[0,0,1]
  v_pk_fma_f32 v[44:45], v[44:45], v[98:99], v[76:77] op_sel_hi:[1,0,1] neg_lo:[0,0,1] neg_hi:[0,0,1]
  v_pk_fma_f32 v[46:47], v[46:47], v[98:99], v[78:79] op_sel_hi:[1,0,1] neg_lo:[0,0,1] neg_hi:[0,0,1]
  v_cvt_pk_bf16_f32 v64, v32, v33
  v_cvt_pk_bf16_f32 v65, v34, v35
  v_cvt_pk_bf16_f32 v66, v36, v37
  v_cvt_pk_bf16_f32 v67, v38, v39
  v_cvt_pk_bf16_f32 v68, v40, v41
  v_cvt_pk_bf16_f32 v69, v42, v43
  v_cvt_pk_bf16_f32 v70, v44, v45
  v_cvt_pk_bf16_f32 v71, v46, v47
  s_add_u32 s30, s30, 2031616
  buffer_store_dwordx4 v[64:67], v13, s[16:19], s30 offen sc1
  s_add_u32 s30, s30, 65536
  buffer_store_dwordx4 v[68:71], v13, s[16:19], s30 offen sc1
  s_endpgm
k1_kernel_r1:
  s_xor_b32 s40, s23, 0
  s_lshl_b32 s44, s40, 11
  s_lshl_b32 s40, s40, 5
  s_xor_b32 s41, s23, 1
  s_lshl_b32 s45, s41, 11
  s_lshl_b32 s41, s41, 5
  s_xor_b32 s42, s23, 2
  s_lshl_b32 s46, s42, 11
  s_lshl_b32 s42, s42, 5
  s_xor_b32 s43, s23, 3
  s_lshl_b32 s47, s43, 11
  s_lshl_b32 s43, s43, 5
  v_and_b32 v4, 31, v1
  v_lshrrev_b32 v5, 5, v1
  v_bfe_u32 v6, v1, 1, 3
  v_xor_b32 v6, v6, v5
  v_lshlrev_b32 v6, 4, v6
  v_lshl_add_u32 v6, v4, 7, v6
  s_lshl_b32 s30, s23, 12
  v_add_u32 v6, s30, v6
  v_xor_b32 v108, s40, v6
  v_xor_b32 v109, s41, v6
  v_xor_b32 v110, s42, v6
  v_xor_b32 v111, s43, v6
  v_lshlrev_b32 v6, 3, v5
  v_bfe_u32 v7, v1, 2, 2
  v_add_u32 v6, v6, v7
  v_lshlrev_b32 v6, 7, v6
  v_lshrrev_b32 v7, 1, v7
  v_xor_b32 v7, s27, v7
  v_lshl_add_u32 v6, v7, 6, v6
  v_bfe_u32 v7, v1, 4, 1
  v_lshl_add_u32 v6, v7, 5, v6
  v_and_b32 v7, 3, v1
  v_lshl_add_u32 v6, v7, 3, v6
  v_add_u32 v112, s44, v6
  v_add_u32 v113, s45, v6
  v_add_u32 v114, s46, v6
  v_add_u32 v115, s47, v6
  v_mov_b32 v100, v108
  v_mov_b32 v101, v109
  v_mov_b32 v102, v110
  v_mov_b32 v103, v111
  v_mov_b32 v104, v112
  v_mov_b32 v105, v113
  v_mov_b32 v106, v114
  v_mov_b32 v107, v115
  v_mov_b32 v16, 0
  v_mov_b32 v17, 0
  v_mov_b32 v18, 0
  v_mov_b32 v19, 0
  v_mov_b32 v20, 0
  v_mov_b32 v21, 0
  v_mov_b32 v22, 0
  v_mov_b32 v23, 0
  v_mov_b32 v24, 0
  v_mov_b32 v25, 0
  v_mov_b32 v26, 0
  v_mov_b32 v27, 0
  v_mov_b32 v28, 0
  v_mov_b32 v29, 0
  v_mov_b32 v30, 0
  v_mov_b32 v31, 0
  v_mov_b32 v116, 0
  v_mov_b32 v117, 0
  v_mov_b32 v118, 0
  v_mov_b32 v119, 0
  v_mov_b32 v120, 0
  v_mov_b32 v121, 0
  v_mov_b32 v122, 0
  v_mov_b32 v123, 0
  s_mov_b32 s26, 0
  s_mov_b32 s25, 0
  s_barrier
  ds_read_b128 v[56:59], v100
  ds_read_b64_tr_b16 v[48:49], v104 offset:24576
  ds_read_b64_tr_b16 v[50:51], v104 offset:25088
  ds_read_b128 v[68:71], v101
  ds_read_b64_tr_b16 v[60:61], v105 offset:24576
  ds_read_b64_tr_b16 v[62:63], v105 offset:25088
k1_kernel_r1_loop:
  s_waitcnt lgkmcnt(3)
  v_mfma_f32_32x32x16_bf16 v[16:31], v[56:59], v[48:51], v[16:31]
  ds_read_b128 v[80:83], v102
  ds_read_b64_tr_b16 v[72:73], v106 offset:24576
  ds_read_b64_tr_b16 v[74:75], v106 offset:25088
  v_lshlrev_b32 v4, 16, v48
  v_lshlrev_b32 v5, 16, v49
  v_and_b32 v8, s28, v48
  v_and_b32 v9, s28, v49
  v_add_f32 v116, v116, v4
  v_add_f32 v118, v118, v5
  v_add_f32 v117, v117, v8
  v_add_f32 v119, v119, v9
  s_waitcnt lgkmcnt(3)
  v_mfma_f32_32x32x16_bf16 v[16:31], v[68:71], v[60:63], v[16:31]
  ds_read_b128 v[92:95], v103
  ds_read_b64_tr_b16 v[84:85], v107 offset:24576
  ds_read_b64_tr_b16 v[86:87], v107 offset:25088
  v_lshlrev_b32 v4, 16, v50
  v_lshlrev_b32 v5, 16, v51
  v_and_b32 v8, s28, v50
  v_and_b32 v9, s28, v51
  v_add_f32 v116, v116, v4
  v_add_f32 v118, v118, v5
  v_add_f32 v117, v117, v8
  v_add_f32 v119, v119, v9
  s_waitcnt lgkmcnt(3)
  s_cmp_ge_u32 s25, 7
  s_cbranch_scc1 L_nb_2
  s_barrier
L_nb_2:
  s_add_u32 s26, s26, 32768
  s_and_b32 s26, s26, 131071
  v_add_u32 v100, s26, v108
  v_add_u32 v101, s26, v109
  v_add_u32 v104, s26, v112
  v_add_u32 v105, s26, v113
  v_mfma_f32_32x32x16_bf16 v[16:31], v[80:83], v[72:75], v[16:31]
  ds_read_b128 v[56:59], v100
  ds_read_b64_tr_b16 v[48:49], v104 offset:24576
  ds_read_b64_tr_b16 v[50:51], v104 offset:25088
  v_lshlrev_b32 v4, 16, v72
  v_lshlrev_b32 v5, 16, v73
  v_and_b32 v8, s28, v72
  v_and_b32 v9, s28, v73
  v_add_f32 v116, v116, v4
  v_add_f32 v118, v118, v5
  v_add_f32 v117, v117, v8
  v_add_f32 v119, v119, v9
  s_waitcnt lgkmcnt(3)
  v_mfma_f32_32x32x16_bf16 v[16:31], v[92:95], v[84:87], v[16:31]
  ds_read_b128 v[68:71], v101
  ds_read_b64_tr_b16 v[60:61], v105 offset:24576
  ds_read_b64_tr_b16 v[62:63], v105 offset:25088
  v_lshlrev_b32 v4, 16, v74
  v_lshlrev_b32 v5, 16, v75
  v_and_b32 v8, s28, v74
  v_and_b32 v9, s28, v75
  v_add_f32 v116, v116, v4
  v_add_f32 v118, v118, v5
  v_add_f32 v117, v117, v8
  v_add_f32 v119, v119, v9
  v_add_u32 v102, s26, v110
  v_add_u32 v103, s26, v111
  v_add_u32 v106, s26, v114
  v_add_u32 v107, s26, v115
  s_add_u32 s25, s25, 1
  s_cmp_lt_u32 s25, 8
  s_cbranch_scc1 k1_kernel_r1_loop
  v_add_f32 v116, v116, v117
  v_add_f32 v118, v118, v119
  v_add_f32 v96, v116, v118
  s_waitcnt lgkmcnt(0)
  v_mov_b32 v4, v96
  v_and_b32 v10, 31, v1
  s_mul_i32 s30, s23, 768
  s_lshl_b32 s31, s27, 7
  s_add_u32 s30, s30, s31
  s_add_u32 s30, s30, 131584
  v_permlane32_swap_b32 v96, v4
  v_lshl_add_u32 v11, v10, 2, s30
  v_add_f32 v96, v96, v4
  ds_write_b32 v11, v96 offset:0
  s_add_u32 s31, s31, 131584
  v_lshl_add_u32 v11, v10, 2, s31
  s_lshl_b32 s30, s23, 7
  s_add_u32 s30, s30, 132608
  v_lshrrev_b32 v12, 5, v1
  v_lshlrev_b32 v12, 4, v12
  v_add_u32 v12, s30, v12
  v_lshlrev_b32 v13, 4, v1
  s_waitcnt lgkmcnt(0)
  s_barrier
  ds_read_b32 v48, v11 offset:0
  ds_read_b32 v49, v11 offset:768
  s_barrier
  ds_read_b128 v[64:67], v12 offset:0
  ds_read_b128 v[80:83], v12 offset:256
  ds_read_b128 v[68:71], v12 offset:32
  ds_read_b128 v[84:87], v12 offset:288
  ds_read_b128 v[72:75], v12 offset:64
  ds_read_b128 v[88:91], v12 offset:320
  ds_read_b128 v[76:79], v12 offset:96
  ds_read_b128 v[92:95], v12 offset:352
  s_waitcnt lgkmcnt(8)
  v_add_f32 v96, v48, v49
  v_bfe_u32 v4, v1, 4, 1
  v_mul_u32_u24 v4, 69632, v4
  v_lshrrev_b32 v5, 5, v1
  v_mul_u32_u24 v5, 272, v5
  v_add_u32 v4, v4, v5
  v_add_u32 v7, 256, v4
  v_and_b32 v5, 3, v1
  v_and_b32 v6, 4, v1
  v_lshl_or_b32 v5, v6, 1, v5
  v_and_b32 v6, 8, v1
  v_lshrrev_b32 v6, 1, v6
  v_or_b32 v5, v5, v6
  v_lshl_add_u32 v4, v5, 4, v4
  s_lshl_b32 s30, s21, 1
  s_add_u32 s30, s30, s27
  s_mul_i32 s30, s30, 139264
  s_mul_i32 s31, s24, 1088
  s_add_u32 s30, s30, s31
  s_add_u32 s30, s30, 4194304
  v_mov_b32 v56, 0x3f803f80
  v_mov_b32 v57, 0x3f803f80
  v_mov_b32 v58, 0x3f803f80
  v_mov_b32 v59, 0x3f803f80
  buffer_store_dwordx4 v[56:59], v7, s[16:19], s30 offen offset:0 sc1
  buffer_store_dwordx4 v[56:59], v7, s[16:19], s30 offen offset:544 sc1
  s_waitcnt lgkmcnt(0)
  v_pk_mul_f32 v[16:17], v[16:17], v[64:65]
  v_pk_mul_f32 v[18:19], v[18:19], v[66:67]
  v_pk_mul_f32 v[20:21], v[20:21], v[68:69]
  v_pk_mul_f32 v[22:23], v[22:23], v[70:71]
  v_pk_mul_f32 v[24:25], v[24:25], v[72:73]
  v_pk_mul_f32 v[26:27], v[26:27], v[74:75]
  v_pk_mul_f32 v[28:29], v[28:29], v[76:77]
  v_pk_mul_f32 v[30:31], v[30:31], v[78:79]
  v_pk_fma_f32 v[16:17], v[80:81], v[96:97], v[16:17] op_sel_hi:[1,0,1] neg_lo:[1,0,0] neg_hi:[1,0,0]
  v_pk_fma_f32 v[18:19], v[82:83], v[96:97], v[18:19] op_sel_hi:[1,0,1] neg_lo:[1,0,0] neg_hi:[1,0,0]
  v_pk_fma_f32 v[20:21], v[84:85], v[96:97], v[20:21] op_sel_hi:[1,0,1] neg_lo:[1,0,0] neg_hi:[1,0,0]
  v_pk_fma_f32 v[22:23], v[86:87], v[96:97], v[22:23] op_sel_hi:[1,0,1] neg_lo:[1,0,0] neg_hi:[1,0,0]
  v_pk_fma_f32 v[24:25], v[88:89], v[96:97], v[24:25] op_sel_hi:[1,0,1] neg_lo:[1,0,0] neg_hi:[1,0,0]
  v_pk_fma_f32 v[26:27], v[90:91], v[96:97], v[26:27] op_sel_hi:[1,0,1] neg_lo:[1,0,0] neg_hi:[1,0,0]
  v_pk_fma_f32 v[28:29], v[92:93], v[96:97], v[28:29] op_sel_hi:[1,0,1] neg_lo:[1,0,0] neg_hi:[1,0,0]
  v_pk_fma_f32 v[30:31], v[94:95], v[96:97], v[30:31] op_sel_hi:[1,0,1] neg_lo:[1,0,0] neg_hi:[1,0,0]
  v_cvt_pk_bf16_f32 v48, v16, v17
  v_cvt_pk_bf16_f32 v49, v18, v19
  v_cvt_pk_bf16_f32 v50, v20, v21
  v_cvt_pk_bf16_f32 v51, v22, v23
  v_cvt_pk_bf16_f32 v52, v24, v25
  v_cvt_pk_bf16_f32 v53, v26, v27
  v_cvt_pk_bf16_f32 v54, v28, v29
  v_cvt_pk_bf16_f32 v55, v30, v31
  buffer_store_dwordx4 v[48:51], v4, s[16:19], s30 offen offset:0 sc1
  buffer_store_dwordx4 v[52:55], v4, s[16:19], s30 offen offset:544 sc1
  s_endpgm
k1_kernel_st:
  s_lshl_b32 s40, s27, 6
  s_add_u32 s41, s40, 32
  v_and_b32 v4, 31, v1
  v_lshrrev_b32 v5, 5, v1
  v_bfe_u32 v6, v1, 1, 3
  v_xor_b32 v6, v6, v5
  v_lshlrev_b32 v6, 4, v6
  v_lshl_add_u32 v6, v4, 7, v6
  s_lshl_b32 s30, s23, 12
  v_add_u32 v6, s30, v6
  v_xor_b32 v46, s40, v6
  v_xor_b32 v47, s41, v6
  v_mov_b32 v44, v46
  v_mov_b32 v45, v47
  v_mov_b32 v64, 0
  v_mov_b32 v65, 0
  v_mov_b32 v66, 0
  v_mov_b32 v67, 0
  v_mov_b32 v68, 0
  v_mov_b32 v69, 0
  v_mov_b32 v70, 0
  v_mov_b32 v71, 0
  s_setprio 2
  s_mov_b32 s26, 0
  s_mov_b32 s25, 0
  s_mov_b32 s52, s21
  s_load_dwordx2 s[40:41], s[0:1], 32
  s_load_dwordx2 s[42:43], s[0:1], 48
  s_load_dwordx2 s[44:45], s[0:1], 16
  s_and_b32 s46, s22, 3
  s_lshl_b32 s47, s2, 2
  s_add_u32 s46, s46, s47
  v_lshlrev_b32 v80, 10, v1
  v_add_u32 v80, s46, v80
  v_lshlrev_b32 v80, 7, v80
  s_waitcnt lgkmcnt(0)
  s_barrier
k1_kernel_st_loop:
  s_cmp_lg_u32 s25, 5
  s_cbranch_scc1 L_pfn_3
  s_mov_b32 s48, s40
  s_mov_b32 s49, s41
  s_mov_b32 s50, 1835008
  s_mov_b32 s51, 0x20000
  buffer_load_dword v81, v80, s[48:51], 0 offen
  s_mov_b32 s48, s42
  s_mov_b32 s49, s43
  s_mov_b32 s50, 1835008
  s_mov_b32 s51, 0x20000
  buffer_load_dword v81, v80, s[48:51], 0 offen
  s_mov_b32 s48, s44
  s_mov_b32 s49, s45
  s_mov_b32 s50, 524288
  s_mov_b32 s51, 0x20000
  buffer_load_dword v81, v80, s[48:51], 0 offen
L_pfn_3:
  ds_read_b128 v[16:19], v44
  ds_read_b128 v[20:23], v45
  s_add_u32 s26, s26, 32768
  s_and_b32 s26, s26, 131071
  v_add_u32 v44, s26, v46
  v_add_u32 v45, s26, v47
  s_waitcnt lgkmcnt(0)
  s_cmp_ge_u32 s25, 7
  s_cbranch_scc1 L_nb_5
  s_barrier
L_nb_5:
  s_cmp_lg_u32 s25, s52
  s_cbranch_scc1 L_nx_4
  v_mov_b32 v32, v16
  v_mov_b32 v33, v17
  v_mov_b32 v34, v18
  v_mov_b32 v35, v19
  v_mov_b32 v36, v20
  v_mov_b32 v37, v21
  v_mov_b32 v38, v22
  v_mov_b32 v39, v23
L_nx_4:
  v_dot2c_f32_bf16 v64, s29, v16
  v_dot2c_f32_bf16 v65, s29, v17
  v_dot2c_f32_bf16 v66, s29, v18
  v_dot2c_f32_bf16 v67, s29, v19
  v_dot2c_f32_bf16 v68, v16, v16
  v_dot2c_f32_bf16 v69, v17, v17
  v_dot2c_f32_bf16 v70, v18, v18
  v_dot2c_f32_bf16 v71, v19, v19
  v_dot2c_f32_bf16 v64, s29, v20
  v_dot2c_f32_bf16 v65, s29, v21
  v_dot2c_f32_bf16 v66, s29, v22
  v_dot2c_f32_bf16 v67, s29, v23
  v_dot2c_f32_bf16 v68, v20, v20
  v_dot2c_f32_bf16 v69, v21, v21
  v_dot2c_f32_bf16 v70, v22, v22
  v_dot2c_f32_bf16 v71, v23, v23
  s_add_u32 s25, s25, 1
  s_cmp_lt_u32 s25, 8
  s_cbranch_scc1 k1_kernel_st_loop
  v_add_f32 v64, v64, v65
  v_add_f32 v66, v66, v67
  v_add_f32 v68, v68, v69
  v_add_f32 v70, v70, v71
  v_add_f32 v40, v64, v66
  v_add_f32 v41, v68, v70
  v_and_b32 v10, 31, v1
  v_mov_b32 v6, v40
  v_mov_b32 v7, v41
  s_lshl_b32 s30, s27, 9
  s_lshl_b32 s31, s23, 8
  s_add_u32 s30, s30, s31
  s_add_u32 s30, s30, 133120
  v_permlane32_swap_b32 v40, v6
  v_permlane32_swap_b32 v41, v7
  v_lshl_add_u32 v11, v10, 3, s30
  v_add_f32 v40, v40, v6
  v_add_f32 v41, v41, v7
  ds_write_b64 v11, v[40:41]
  s_add_u32 s31, s31, 133120
  v_lshl_add_u32 v11, v10, 3, s31
  s_waitcnt lgkmcnt(0)
  s_barrier
  ds_read_b64 v[40:41], v11
  ds_read_b64 v[42:43], v11 offset:512
  s_lshl_b32 s30, s23, 7
  s_add_u32 s30, s30, 132608
  v_lshl_add_u32 v11, v10, 2, s30
  s_waitcnt lgkmcnt(0)
  v_add_f32 v40, v40, v42
  v_add_f32 v41, v41, v43
  v_mul_f32 v40, 0x3b000000, v40
  v_mul_f32 v41, 0x3b000000, v41
  v_fma_f32 v41, -v40, v40, v41
  v_max_f32 v41, 0, v41
  v_add_f32 v41, 0x3727c5ac, v41
  v_rsq_f32 v42, v41
  s_nop 0
  v_mul_f32 v43, v40, v42
  ds_write_b32 v11, v42
  ds_write_b32 v11, v43 offset:256
  s_waitcnt lgkmcnt(0)
  s_barrier
  v_lshlrev_b32 v4, 16, v32
  v_and_b32 v5, 0xffff0000, v32
  v_fma_f32 v4, v4, v42, -v43
  v_fma_f32 v5, v5, v42, -v43
  v_cvt_pk_bf16_f32 v32, v4, v5
  v_lshlrev_b32 v6, 16, v33
  v_and_b32 v7, 0xffff0000, v33
  v_fma_f32 v6, v6, v42, -v43
  v_fma_f32 v7, v7, v42, -v43
  v_cvt_pk_bf16_f32 v33, v6, v7
  v_lshlrev_b32 v4, 16, v34
  v_and_b32 v5, 0xffff0000, v34
  v_fma_f32 v4, v4, v42, -v43
  v_fma_f32 v5, v5, v42, -v43
  v_cvt_pk_bf16_f32 v34, v4, v5
  v_lshlrev_b32 v6, 16, v35
  v_and_b32 v7, 0xffff0000, v35
  v_fma_f32 v6, v6, v42, -v43
  v_fma_f32 v7, v7, v42, -v43
  v_cvt_pk_bf16_f32 v35, v6, v7
  v_lshlrev_b32 v4, 16, v36
  v_and_b32 v5, 0xffff0000, v36
  v_fma_f32 v4, v4, v42, -v43
  v_fma_f32 v5, v5, v42, -v43
  v_cvt_pk_bf16_f32 v36, v4, v5
  v_lshlrev_b32 v6, 16, v37
  v_and_b32 v7, 0xffff0000, v37
  v_fma_f32 v6, v6, v42, -v43
  v_fma_f32 v7, v7, v42, -v43
  v_cvt_pk_bf16_f32 v37, v6, v7
  v_lshlrev_b32 v4, 16, v38
  v_and_b32 v5, 0xffff0000, v38
  v_fma_f32 v4, v4, v42, -v43
  v_fma_f32 v5, v5, v42, -v43
  v_cvt_pk_bf16_f32 v38, v4, v5
  v_lshlrev_b32 v6, 16, v39
  v_and_b32 v7, 0xffff0000, v39
  v_fma_f32 v6, v6, v42, -v43
  v_fma_f32 v7, v7, v42, -v43
  v_cvt_pk_bf16_f32 v39, v6, v7
  s_lshl_b32 s30, s24, 5
  s_lshl_b32 s31, s21, 2
  s_add_u32 s30, s30, s31
  s_lshl_b32 s31, s27, 1
  s_add_u32 s30, s30, s31
  s_lshl_b32 s30, s30, 10
  s_add_u32 s30, s30, 6815744
  v_lshlrev_b32 v13, 4, v1
  buffer_store_dwordx4 v[32:35], v13, s[16:19], s30 offen offset:0 sc1
  buffer_store_dwordx4 v[36:39], v13, s[16:19], s30 offen offset:1024 sc1
  s_endpgm
k1_kernel_exit:
  s_endpgm
.globl k2_kernel
.p2align 8
.type k2_kernel,@function
k2_kernel:
  s_cmp_ge_u32 s2, 256
  s_cbranch_scc1 k2_kernel_exit
  s_load_dwordx2 s[8:9], s[0:1], 80
  s_load_dwordx4 s[60:63], s[0:1], 32
  s_load_dwordx4 s[64:67], s[0:1], 48
  s_load_dwordx2 s[80:81], s[0:1], 16
  s_load_dwordx2 s[82:83], s[0:1], 0
  s_load_dwordx2 s[84:85], s[0:1], 64
  v_lshrrev_b32 v4, 6, v0
  v_and_b32 v1, 63, v0
  v_readfirstlane_b32 s14, v4
  s_and_b32 s20, s2, 7
  s_lshl_b32 s20, s20, 2
  s_lshr_b32 s21, s2, 3
  s_and_b32 s21, s21, 3
  s_add_u32 s12, s20, s21
  s_lshr_b32 s13, s2, 5
  s_mov_b32 s10, 21495808
  s_mov_b32 s11, 0x20000
  s_waitcnt lgkmcnt(0)
  s_cmp_ge_u32 s14, 8
  s_cbranch_scc0 k2_kernel_attn
  s_sub_u32 s30, s14, 8
  s_mul_i32 s31, s30, 6144
  s_add_u32 s31, s31, 135168
  v_mov_b32 v2, 159744
  v_mov_b32 v3, 0
  ds_write_b32 v2, v3
  ds_write_b32 v2, v3 offset:8
  ds_write_b32 v2, v3 offset:16
  ds_write_b32 v2, v3 offset:24
  ds_write_b32 v2, v3 offset:28
  s_mov_b32 s38, 0
  s_sub_u32 s20, s14, 8
  v_lshlrev_b32 v13, 4, v1
  s_lshl_b32 s21, s12, 16
  s_add_u32 s21, s21, 2097152
  s_mul_i32 s22, s12, 69632
  s_add_u32 s22, s22, 4194304
  v_mov_b32 v5, 159748
  v_mov_b32 v6, 0
  ds_write_b32 v5, v6
  ds_write_b32 v5, v6 offset:8
  s_lshl_b32 s23, s20, 11
  s_mul_i32 s24, s20, 3072
  s_add_u32 m0, s23, 0
  s_add_u32 s25, s21, s23
  buffer_load_dwordx4 v13, s[8:11], s25 offen lds
  s_add_u32 m0, s23, 1024
  s_add_u32 s25, s21, s23
  s_add_u32 s25, s25, 1024
  buffer_load_dwordx4 v13, s[8:11], s25 offen lds
  s_add_u32 m0, s24, 65536
  s_add_u32 s25, s22, s24
  buffer_load_dwordx4 v13, s[8:11], s25 offen lds
  s_add_u32 m0, s24, 66560
  s_add_u32 s25, s22, s24
  s_add_u32 s25, s25, 1024
  buffer_load_dwordx4 v13, s[8:11], s25 offen lds
  s_add_u32 m0, s24, 67584
  s_add_u32 s25, s22, s24
  s_add_u32 s25, s25, 2048
  buffer_load_dwordx4 v13, s[8:11], s25 offen lds
  s_waitcnt vmcnt(0) lgkmcnt(0)
  s_barrier
  s_lshl_b32 s23, s20, 10
  s_min_u32 s24, s23, 1024
  s_add_u32 m0, s23, 8192
  s_add_u32 s25, s21, s23
  s_add_u32 s25, s25, 8192
  buffer_load_dwordx4 v13, s[8:11], s25 offen lds
  s_add_u32 m0, s23, 77824
  s_add_u32 s25, s22, s23
  s_add_u32 s25, s25, 12288
  buffer_load_dwordx4 v13, s[8:11], s25 offen lds
  s_add_u32 m0, s23, 12288
  s_add_u32 s25, s21, s23
  s_add_u32 s25, s25, 12288
  buffer_load_dwordx4 v13, s[8:11], s25 offen lds
  s_add_u32 m0, s23, 81920
  s_add_u32 s25, s22, s23
  s_add_u32 s25, s25, 16384
  buffer_load_dwordx4 v13, s[8:11], s25 offen lds
  s_add_u32 m0, s23, 16384
  s_add_u32 s25, s21, s23
  s_add_u32 s25, s25, 16384
  buffer_load_dwordx4 v13, s[8:11], s25 offen lds
  s_add_u32 m0, s23, 86016
  s_add_u32 s25, s22, s23
  s_add_u32 s25, s25, 20480
  buffer_load_dwordx4 v13, s[8:11], s25 offen lds
  s_add_u32 m0, s23, 20480
  s_add_u32 s25, s21, s23
  s_add_u32 s25, s25, 20480
  buffer_load_dwordx4 v13, s[8:11], s25 offen lds
  s_add_u32 m0, s23, 90112
  s_add_u32 s25, s22, s23
  s_add_u32 s25, s25, 24576
  buffer_load_dwordx4 v13, s[8:11], s25 offen lds
  s_add_u32 m0, s23, 24576
  s_add_u32 s25, s21, s23
  s_add_u32 s25, s25, 24576
  buffer_load_dwordx4 v13, s[8:11], s25 offen lds
  s_add_u32 m0, s23, 94208
  s_add_u32 s25, s22, s23
  s_add_u32 s25, s25, 28672
  buffer_load_dwordx4 v13, s[8:11], s25 offen lds
  s_add_u32 m0, s23, 28672
  s_add_u32 s25, s21, s23
  s_add_u32 s25, s25, 28672
  buffer_load_dwordx4 v13, s[8:11], s25 offen lds
  s_add_u32 m0, s24, 98304
  s_add_u32 s25, s22, s24
  s_add_u32 s25, s25, 32768
  buffer_load_dwordx4 v13, s[8:11], s25 offen lds
  s_setprio 3
  v_lshlrev_b32 v13, 4, v1
  v_add_u32 v9, 32768, v13
  v_add_u32 v10, 100352, v13
  s_and_b32 s36, s13, 1
  s_lshl_b32 s36, s36, 2
  s_add_u32 s36, s36, s30
  s_mov_b32 s68, 0
  s_cmp_ge_u32 s36, 7
  s_cbranch_scc1 k2_kernel_idlef1
  s_mov_b32 s68, 1
  s_lshr_b32 s37, s13, 1
  s_mul_i32 s44, s37, 7
  s_add_u32 s44, s44, s36
  s_lshr_b32 s45, s12, 2
  s_and_b32 s46, s12, 3
  s_lshl_b32 s46, s46, 3
  s_add_u32 s45, s45, s46
  s_lshl_b32 s45, s45, 11
  s_lshl_b32 s46, s37, 7
  s_add_u32 s45, s45, s46
  s_lshl_b32 s46, s36, 2
  s_add_u32 s45, s45, s46
  s_add_u32 s45, s45, 20972160
  s_mov_b32 s52, s60
  s_mov_b32 s53, s61
  s_mov_b32 s54, 1835008
  s_mov_b32 s55, 0x20000
  s_mov_b32 s56, s62
  s_mov_b32 s57, s63
  s_mov_b32 s58, 3584
  s_mov_b32 s59, 0x20000
  v_lshrrev_b32 v4, 5, v1
  v_lshlrev_b32 v4, 3, v4
  s_lshl_b32 s46, s44, 7
  buffer_load_dwordx2 v[112:113], v4, s[56:59], s46 offen offset:0
  buffer_load_dwordx2 v[114:115], v4, s[56:59], s46 offen offset:16
  buffer_load_dwordx2 v[116:117], v4, s[56:59], s46 offen offset:32
  buffer_load_dwordx2 v[118:119], v4, s[56:59], s46 offen offset:48
  buffer_load_dwordx2 v[120:121], v4, s[56:59], s46 offen offset:64
  buffer_load_dwordx2 v[122:123], v4, s[56:59], s46 offen offset:80
  buffer_load_dwordx2 v[124:125], v4, s[56:59], s46 offen offset:96
  buffer_load_dwordx2 v[126:127], v4, s[56:59], s46 offen offset:112
  v_lshrrev_b32 v4, 3, v1
  v_and_b32 v5, 7, v1
  v_bfe_u32 v6, v1, 4, 1
  v_lshlrev_b32 v6, 2, v6
  v_xor_b32 v5, v5, v6
  v_lshlrev_b32 v5, 4, v5
  v_mul_u32_u24 v4, 3584, v4
  v_add_u32 v12, v4, v5
  v_lshrrev_b32 v4, 5, v1
  v_lshlrev_b32 v4, 3, v4
  v_bfe_u32 v5, v1, 2, 2
  v_add_u32 v4, v4, v5
  v_lshlrev_b32 v4, 7, v4
  v_lshrrev_b32 v5, 1, v5
  v_lshl_add_u32 v4, v5, 6, v4
  v_bfe_u32 v5, v1, 4, 1
  v_lshl_add_u32 v4, v5, 5, v4
  v_and_b32 v5, 3, v1
  v_lshl_add_u32 v4, v5, 3, v4
  v_add_u32 v14, s31, v4
  v_xor_b32 v15, 64, v14
  v_lshlrev_b32 v4, 4, v1
  v_add_u32 v11, s31, v4
  s_lshl_b32 s32, s44, 7
  s_lshl_b32 s46, s12, 1
  s_lshl_b32 s46, s46, 15
  s_add_u32 s33, s46, 6815744
  s_lshl_b32 s46, s12, 1
  s_add_u32 s46, s46, 1
  s_lshl_b32 s46, s46, 15
  s_add_u32 s34, s46, 6815744
  s_add_u32 m0, s31, 0
  s_add_u32 s36, s32, 0
  buffer_load_dwordx4 v12, s[52:55], s36 offen lds
  s_add_u32 m0, s31, 1024
  s_add_u32 s36, s32, 28672
  buffer_load_dwordx4 v12, s[52:55], s36 offen lds
  s_add_u32 s32, s32, 57344
  buffer_load_dwordx4 v[80:83], v13, s[8:11], s33 offen
  buffer_load_dwordx4 v[84:87], v13, s[8:11], s34 offen
  s_add_u32 s33, s33, 1024
  s_add_u32 s34, s34, 1024
  s_add_u32 m0, s31, 2048
  s_add_u32 s36, s32, 0
  buffer_load_dwordx4 v12, s[52:55], s36 offen lds
  s_add_u32 m0, s31, 3072
  s_add_u32 s36, s32, 28672
  buffer_load_dwordx4 v12, s[52:55], s36 offen lds
  s_add_u32 s32, s32, 57344
  buffer_load_dwordx4 v[88:91], v13, s[8:11], s33 offen
  buffer_load_dwordx4 v[92:95], v13, s[8:11], s34 offen
  s_add_u32 s33, s33, 1024
  s_add_u32 s34, s34, 1024
  s_add_u32 m0, s31, 4096
  s_add_u32 s36, s32, 0
  buffer_load_dwordx4 v12, s[52:55], s36 offen lds
  s_add_u32 m0, s31, 5120
  s_add_u32 s36, s32, 28672
  buffer_load_dwordx4 v12, s[52:55], s36 offen lds
  s_add_u32 s32, s32, 57344
  buffer_load_dwordx4 v[96:99], v13, s[8:11], s33 offen
  buffer_load_dwordx4 v[100:103], v13, s[8:11], s34 offen
  s_add_u32 s33, s33, 1024
  s_add_u32 s34, s34, 1024
  buffer_load_dwordx4 v[104:107], v13, s[8:11], s33 offen
  buffer_load_dwordx4 v[108:111], v13, s[8:11], s34 offen
  s_add_u32 s33, s33, 1024
  s_add_u32 s34, s34, 1024
  s_waitcnt vmcnt(22)
  v_mov_b32 v2, 159748
  v_mov_b32 v3, 1
  s_mov_b64 s[26:27], exec
  s_mov_b64 exec, 1
  ds_add_u32 v2, v3
  s_mov_b64 exec, s[26:27]
  s_waitcnt vmcnt(14)
  v_lshlrev_b32 v16, 16, v112
  v_and_b32 v17, 0xffff0000, v112
  v_lshlrev_b32 v18, 16, v113
  v_and_b32 v19, 0xffff0000, v113
  v_lshlrev_b32 v20, 16, v114
  v_and_b32 v21, 0xffff0000, v114
  v_lshlrev_b32 v22, 16, v115
  v_and_b32 v23, 0xffff0000, v115
  v_lshlrev_b32 v24, 16, v116
  v_and_b32 v25, 0xffff0000, v116
  v_lshlrev_b32 v26, 16, v117
  v_and_b32 v27, 0xffff0000, v117
  v_lshlrev_b32 v28, 16, v118
  v_and_b32 v29, 0xffff0000, v118
  v_lshlrev_b32 v30, 16, v119
  v_and_b32 v31, 0xffff0000, v119
  v_lshlrev_b32 v48, 16, v120
  v_and_b32 v49, 0xffff0000, v120
  v_lshlrev_b32 v50, 16, v121
  v_and_b32 v51, 0xffff0000, v121
  v_lshlrev_b32 v52, 16, v122
  v_and_b32 v53, 0xffff0000, v122
  v_lshlrev_b32 v54, 16, v123
  v_and_b32 v55, 0xffff0000, v123
  v_lshlrev_b32 v56, 16, v124
  v_and_b32 v57, 0xffff0000, v124
  v_lshlrev_b32 v58, 16, v125
  v_and_b32 v59, 0xffff0000, v125
  v_lshlrev_b32 v60, 16, v126
  v_and_b32 v61, 0xffff0000, v126
  v_lshlrev_b32 v62, 16, v127
  v_and_b32 v63, 0xffff0000, v127
  s_setprio 0
  s_waitcnt vmcnt(10)
  ds_read_b64_tr_b16 v[112:113], v14 offset:0
  ds_read_b64_tr_b16 v[114:115], v14 offset:512
  ds_read_b64_tr_b16 v[116:117], v15 offset:0
  ds_read_b64_tr_b16 v[118:119], v15 offset:512
  s_waitcnt vmcnt(8)
  ds_read_b64_tr_b16 v[120:121], v14 offset:2048
  ds_read_b64_tr_b16 v[122:123], v14 offset:2560
  ds_read_b64_tr_b16 v[124:125], v15 offset:2048
  ds_read_b64_tr_b16 v[126:127], v15 offset:2560
  s_waitcnt lgkmcnt(4)
  v_mfma_f32_32x32x16_bf16 v[32:47], v[112:115], v[84:87], v[16:31]
  v_mfma_f32_32x32x16_bf16 v[16:31], v[112:115], v[80:83], v[16:31]
  s_add_u32 m0, s31, 0
  s_add_u32 s36, s32, 0
  buffer_load_dwordx4 v12, s[52:55], s36 offen lds
  s_add_u32 m0, s31, 1024
  s_add_u32 s36, s32, 28672
  buffer_load_dwordx4 v12, s[52:55], s36 offen lds
  s_add_u32 s32, s32, 57344
  s_add_u32 m0, s23, 32768
  s_add_u32 s25, s21, s23
  s_add_u32 s25, s25, 32768
  buffer_load_dwordx4 v13, s[8:11], s25 offen lds
  s_add_u32 m0, s23, 100352
  s_add_u32 s25, s22, s23
  s_add_u32 s25, s25, 34816
  buffer_load_dwordx4 v13, s[8:11], s25 offen lds
  s_add_u32 m0, s23, 36864
  s_add_u32 s25, s21, s23
  s_add_u32 s25, s25, 36864
  buffer_load_dwordx4 v13, s[8:11], s25 offen lds
  s_add_u32 m0, s23, 104448
  s_add_u32 s25, s22, s23
  s_add_u32 s25, s25, 38912
  buffer_load_dwordx4 v13, s[8:11], s25 offen lds
  s_add_u32 m0, s23, 40960
  s_add_u32 s25, s21, s23
  s_add_u32 s25, s25, 40960
  buffer_load_dwordx4 v13, s[8:11], s25 offen lds
  s_add_u32 m0, s23, 108544
  s_add_u32 s25, s22, s23
  s_add_u32 s25, s25, 43008
  buffer_load_dwordx4 v13, s[8:11], s25 offen lds
  s_add_u32 m0, s23, 45056
  s_add_u32 s25, s21, s23
  s_add_u32 s25, s25, 45056
  buffer_load_dwordx4 v13, s[8:11], s25 offen lds
  s_add_u32 m0, s23, 112640
  s_add_u32 s25, s22, s23
  s_add_u32 s25, s25, 47104
  buffer_load_dwordx4 v13, s[8:11], s25 offen lds
  s_add_u32 m0, s23, 49152
  s_add_u32 s25, s21, s23
  s_add_u32 s25, s25, 49152
  buffer_load_dwordx4 v13, s[8:11], s25 offen lds
  s_add_u32 m0, s23, 116736
  s_add_u32 s25, s22, s23
  s_add_u32 s25, s25, 51200
  buffer_load_dwordx4 v13, s[8:11], s25 offen lds
  s_add_u32 m0, s23, 53248
  s_add_u32 s25, s21, s23
  s_add_u32 s25, s25, 53248
  buffer_load_dwordx4 v13, s[8:11], s25 offen lds
  s_add_u32 m0, s23, 120832
  s_add_u32 s25, s22, s23
  s_add_u32 s25, s25, 55296
  buffer_load_dwordx4 v13, s[8:11], s25 offen lds
  s_add_u32 m0, s23, 57344
  s_add_u32 s25, s21, s23
  s_add_u32 s25, s25, 57344
  buffer_load_dwordx4 v13, s[8:11], s25 offen lds
  s_add_u32 m0, s23, 124928
  s_add_u32 s25, s22, s23
  s_add_u32 s25, s25, 59392
  buffer_load_dwordx4 v13, s[8:11], s25 offen lds
  s_add_u32 m0, s23, 61440
  s_add_u32 s25, s21, s23
  s_add_u32 s25, s25, 61440
  buffer_load_dwordx4 v13, s[8:11], s25 offen lds
  s_add_u32 m0, s23, 129024
  s_add_u32 s25, s22, s23
  s_add_u32 s25, s25, 63488
  buffer_load_dwordx4 v13, s[8:11], s25 offen lds
  s_add_u32 m0, s24, 133120
  s_add_u32 s25, s22, s24
  s_add_u32 s25, s25, 67584
  buffer_load_dwordx4 v13, s[8:11], s25 offen lds
  v_mfma_f32_32x32x16_bf16 v[64:79], v[116:119], v[84:87], v[48:63]
  v_mfma_f32_32x32x16_bf16 v[48:63], v[116:119], v[80:83], v[48:63]
  buffer_load_dwordx4 v[80:83], v13, s[8:11], s33 offen
  buffer_load_dwordx4 v[84:87], v13, s[8:11], s34 offen
  s_add_u32 s33, s33, 1024
  s_add_u32 s34, s34, 1024
  s_waitcnt vmcnt(25)
  ds_read_b64_tr_b16 v[112:113], v14 offset:4096
  ds_read_b64_tr_b16 v[114:115], v14 offset:4608
  ds_read_b64_tr_b16 v[116:117], v15 offset:4096
  ds_read_b64_tr_b16 v[118:119], v15 offset:4608
  s_waitcnt lgkmcnt(4)
  v_mfma_f32_32x32x16_bf16 v[16:31], v[120:123], v[88:91], v[16:31]
  v_mfma_f32_32x32x16_bf16 v[32:47], v[120:123], v[92:95], v[32:47]
  s_add_u32 m0, s31, 2048
  s_add_u32 s36, s32, 0
  buffer_load_dwordx4 v12, s[52:55], s36 offen lds
  s_add_u32 m0, s31, 3072
  s_add_u32 s36, s32, 28672
  buffer_load_dwordx4 v12, s[52:55], s36 offen lds
  s_add_u32 s32, s32, 57344
  v_mfma_f32_32x32x16_bf16 v[48:63], v[124:127], v[88:91], v[48:63]
  v_mfma_f32_32x32x16_bf16 v[64:79], v[124:127], v[92:95], v[64:79]
  buffer_load_dwordx4 v[88:91], v13, s[8:11], s33 offen
  buffer_load_dwordx4 v[92:95], v13, s[8:11], s34 offen
  s_add_u32 s33, s33, 1024
  s_add_u32 s34, s34, 1024
  s_waitcnt vmcnt(23)
  ds_read_b64_tr_b16 v[120:121], v14 offset:0
  ds_read_b64_tr_b16 v[122:123], v14 offset:512
  ds_read_b64_tr_b16 v[124:125], v15 offset:0
  ds_read_b64_tr_b16 v[126:127], v15 offset:512
  s_waitcnt lgkmcnt(4)
  v_mfma_f32_32x32x16_bf16 v[16:31], v[112:115], v[96:99], v[16:31]
  v_mfma_f32_32x32x16_bf16 v[32:47], v[112:115], v[100:103], v[32:47]
  s_add_u32 m0, s31, 4096
  s_add_u32 s36, s32, 0
  buffer_load_dwordx4 v12, s[52:55], s36 offen lds
  s_add_u32 m0, s31, 5120
  s_add_u32 s36, s32, 28672
  buffer_load_dwordx4 v12, s[52:55], s36 offen lds
  s_add_u32 s32, s32, 57344
  v_mfma_f32_32x32x16_bf16 v[48:63], v[116:119], v[96:99], v[48:63]
  v_mfma_f32_32x32x16_bf16 v[64:79], v[116:119], v[100:103], v[64:79]
  buffer_load_dwordx4 v[96:99], v13, s[8:11], s33 offen
  buffer_load_dwordx4 v[100:103], v13, s[8:11], s34 offen
  s_add_u32 s33, s33, 1024
  s_add_u32 s34, s34, 1024
  s_waitcnt vmcnt(6)
  ds_read_b64_tr_b16 v[112:113], v14 offset:2048
  ds_read_b64_tr_b16 v[114:115], v14 offset:2560
  ds_read_b64_tr_b16 v[116:117], v15 offset:2048
  ds_read_b64_tr_b16 v[118:119], v15 offset:2560
  s_waitcnt lgkmcnt(4)
  v_mfma_f32_32x32x16_bf16 v[16:31], v[120:123], v[104:107], v[16:31]
  v_mfma_f32_32x32x16_bf16 v[32:47], v[120:123], v[108:111], v[32:47]
  s_add_u32 m0, s31, 0
  s_add_u32 s36, s32, 0
  buffer_load_dwordx4 v12, s[52:55], s36 offen lds
  s_add_u32 m0, s31, 1024
  s_add_u32 s36, s32, 28672
  buffer_load_dwordx4 v12, s[52:55], s36 offen lds
  s_add_u32 s32, s32, 57344
  v_mfma_f32_32x32x16_bf16 v[48:63], v[124:127], v[104:107], v[48:63]
  v_mfma_f32_32x32x16_bf16 v[64:79], v[124:127], v[108:111], v[64:79]
  buffer_load_dwordx4 v[104:107], v13, s[8:11], s33 offen
  buffer_load_dwordx4 v[108:111], v13, s[8:11], s34 offen
  s_add_u32 s33, s33, 1024
  s_add_u32 s34, s34, 1024
  s_waitcnt vmcnt(6)
  ds_read_b64_tr_b16 v[120:121], v14 offset:4096
  ds_read_b64_tr_b16 v[122:123], v14 offset:4608
  ds_read_b64_tr_b16 v[124:125], v15 offset:4096
  ds_read_b64_tr_b16 v[126:127], v15 offset:4608
  s_waitcnt lgkmcnt(4)
  v_mfma_f32_32x32x16_bf16 v[16:31], v[112:115], v[80:83], v[16:31]
  v_mfma_f32_32x32x16_bf16 v[32:47], v[112:115], v[84:87], v[32:47]
  s_add_u32 m0, s31, 2048
  s_add_u32 s36, s32, 0
  buffer_load_dwordx4 v12, s[52:55], s36 offen lds
  s_add_u32 m0, s31, 3072
  s_add_u32 s36, s32, 28672
  buffer_load_dwordx4 v12, s[52:55], s36 offen lds
  s_add_u32 s32, s32, 57344
  v_mfma_f32_32x32x16_bf16 v[48:63], v[116:119], v[80:83], v[48:63]
  v_mfma_f32_32x32x16_bf16 v[64:79], v[116:119], v[84:87], v[64:79]
  buffer_load_dwordx4 v[80:83], v13, s[8:11], s33 offen
  buffer_load_dwordx4 v[84:87], v13, s[8:11], s34 offen
  s_add_u32 s33, s33, 1024
  s_add_u32 s34, s34, 1024
  s_waitcnt vmcnt(6)
  ds_read_b64_tr_b16 v[112:113], v14 offset:0
  ds_read_b64_tr_b16 v[114:115], v14 offset:512
  ds_read_b64_tr_b16 v[116:117], v15 offset:0
  ds_read_b64_tr_b16 v[118:119], v15 offset:512
  s_waitcnt lgkmcnt(4)
  v_mfma_f32_32x32x16_bf16 v[16:31], v[120:123], v[88:91], v[16:31]
  v_mfma_f32_32x32x16_bf16 v[32:47], v[120:123], v[92:95], v[32:47]
  s_add_u32 m0, s31, 4096
  s_add_u32 s36, s32, 0
  buffer_load_dwordx4 v12, s[52:55], s36 offen lds
  s_add_u32 m0, s31, 5120
  s_add_u32 s36, s32, 28672
  buffer_load_dwordx4 v12, s[52:55], s36 offen lds
  s_add_u32 s32, s32, 57344
  v_mfma_f32_32x32x16_bf16 v[48:63], v[124:127], v[88:91], v[48:63]
  v_mfma_f32_32x32x16_bf16 v[64:79], v[124:127], v[92:95], v[64:79]
  buffer_load_dwordx4 v[88:91], v13, s[8:11], s33 offen
  buffer_load_dwordx4 v[92:95], v13, s[8:11], s34 offen
  s_add_u32 s33, s33, 1024
  s_add_u32 s34, s34, 1024
  s_waitcnt vmcnt(6)
  ds_read_b64_tr_b16 v[120:121], v14 offset:2048
  ds_read_b64_tr_b16 v[122:123], v14 offset:2560
  ds_read_b64_tr_b16 v[124:125], v15 offset:2048
  ds_read_b64_tr_b16 v[126:127], v15 offset:2560
  s_waitcnt lgkmcnt(4)
  v_mfma_f32_32x32x16_bf16 v[16:31], v[112:115], v[96:99], v[16:31]
  v_mfma_f32_32x32x16_bf16 v[32:47], v[112:115], v[100:103], v[32:47]
  s_add_u32 m0, s31, 0
  s_add_u32 s36, s32, 0
  buffer_load_dwordx4 v12, s[52:55], s36 offen lds
  s_add_u32 m0, s31, 1024
  s_add_u32 s36, s32, 28672
  buffer_load_dwordx4 v12, s[52:55], s36 offen lds
  s_add_u32 s32, s32, 57344
  v_mov_b32 v2, 159756
  v_mov_b32 v3, 1
  s_mov_b64 s[26:27], exec
  s_mov_b64 exec, 1
  ds_add_u32 v2, v3
  s_mov_b64 exec, s[26:27]
  v_mfma_f32_32x32x16_bf16 v[48:63], v[116:119], v[96:99], v[48:63]
  v_mfma_f32_32x32x16_bf16 v[64:79], v[116:119], v[100:103], v[64:79]
  buffer_load_dwordx4 v[96:99], v13, s[8:11], s33 offen
  buffer_load_dwordx4 v[100:103], v13, s[8:11], s34 offen
  s_add_u32 s33, s33, 1024
  s_add_u32 s34, s34, 1024
  s_waitcnt vmcnt(6)
  ds_read_b64_tr_b16 v[112:113], v14 offset:4096
  ds_read_b64_tr_b16 v[114:115], v14 offset:4608
  ds_read_b64_tr_b16 v[116:117], v15 offset:4096
  ds_read_b64_tr_b16 v[118:119], v15 offset:4608
  s_waitcnt lgkmcnt(4)
  v_mfma_f32_32x32x16_bf16 v[16:31], v[120:123], v[104:107], v[16:31]
  v_mfma_f32_32x32x16_bf16 v[32:47], v[120:123], v[108:111], v[32:47]
  s_add_u32 m0, s31, 2048
  s_add_u32 s36, s32, 0
  buffer_load_dwordx4 v12, s[52:55], s36 offen lds
  s_add_u32 m0, s31, 3072
  s_add_u32 s36, s32, 28672
  buffer_load_dwordx4 v12, s[52:55], s36 offen lds
  s_add_u32 s32, s32, 57344
  v_mfma_f32_32x32x16_bf16 v[48:63], v[124:127], v[104:107], v[48:63]
  v_mfma_f32_32x32x16_bf16 v[64:79], v[124:127], v[108:111], v[64:79]
  buffer_load_dwordx4 v[104:107], v13, s[8:11], s33 offen
  buffer_load_dwordx4 v[108:111], v13, s[8:11], s34 offen
  s_add_u32 s33, s33, 1024
  s_add_u32 s34, s34, 1024
  s_waitcnt vmcnt(6)
  ds_read_b64_tr_b16 v[120:121], v14 offset:0
  ds_read_b64_tr_b16 v[122:123], v14 offset:512
  ds_read_b64_tr_b16 v[124:125], v15 offset:0
  ds_read_b64_tr_b16 v[126:127], v15 offset:512
  s_waitcnt lgkmcnt(4)
  v_mfma_f32_32x32x16_bf16 v[16:31], v[112:115], v[80:83], v[16:31]
  v_mfma_f32_32x32x16_bf16 v[32:47], v[112:115], v[84:87], v[32:47]
  s_add_u32 m0, s31, 4096
  s_add_u32 s36, s32, 0
  buffer_load_dwordx4 v12, s[52:55], s36 offen lds
  s_add_u32 m0, s31, 5120
  s_add_u32 s36, s32, 28672
  buffer_load_dwordx4 v12, s[52:55], s36 offen lds
  s_add_u32 s32, s32, 57344
  v_mfma_f32_32x32x16_bf16 v[48:63], v[116:119], v[80:83], v[48:63]
  v_mfma_f32_32x32x16_bf16 v[64:79], v[116:119], v[84:87], v[64:79]
  buffer_load_dwordx4 v[80:83], v13, s[8:11], s33 offen
  buffer_load_dwordx4 v[84:87], v13, s[8:11], s34 offen
  s_add_u32 s33, s33, 1024
  s_add_u32 s34, s34, 1024
  s_waitcnt vmcnt(6)
  ds_read_b64_tr_b16 v[112:113], v14 offset:2048
  ds_read_b64_tr_b16 v[114:115], v14 offset:2560
  ds_read_b64_tr_b16 v[116:117], v15 offset:2048
  ds_read_b64_tr_b16 v[118:119], v15 offset:2560
  s_waitcnt lgkmcnt(4)
  v_mfma_f32_32x32x16_bf16 v[16:31], v[120:123], v[88:91], v[16:31]
  v_mfma_f32_32x32x16_bf16 v[32:47], v[120:123], v[92:95], v[32:47]
  s_add_u32 m0, s31, 0
  s_add_u32 s36, s32, 0
  buffer_load_dwordx4 v12, s[52:55], s36 offen lds
  s_add_u32 m0, s31, 1024
  s_add_u32 s36, s32, 28672
  buffer_load_dwordx4 v12, s[52:55], s36 offen lds
  s_add_u32 s32, s32, 57344
  v_mfma_f32_32x32x16_bf16 v[48:63], v[124:127], v[88:91], v[48:63]
  v_mfma_f32_32x32x16_bf16 v[64:79], v[124:127], v[92:95], v[64:79]
  buffer_load_dwordx4 v[88:91], v13, s[8:11], s33 offen
  buffer_load_dwordx4 v[92:95], v13, s[8:11], s34 offen
  s_add_u32 s33, s33, 1024
  s_add_u32 s34, s34, 1024
  s_waitcnt vmcnt(6)
  ds_read_b64_tr_b16 v[120:121], v14 offset:4096
  ds_read_b64_tr_b16 v[122:123], v14 offset:4608
  ds_read_b64_tr_b16 v[124:125], v15 offset:4096
  ds_read_b64_tr_b16 v[126:127], v15 offset:4608
  s_waitcnt lgkmcnt(4)
  v_mfma_f32_32x32x16_bf16 v[16:31], v[112:115], v[96:99], v[16:31]
  v_mfma_f32_32x32x16_bf16 v[32:47], v[112:115], v[100:103], v[32:47]
  s_add_u32 m0, s31, 2048
  s_add_u32 s36, s32, 0
  buffer_load_dwordx4 v12, s[52:55], s36 offen lds
  s_add_u32 m0, s31, 3072
  s_add_u32 s36, s32, 28672
  buffer_load_dwordx4 v12, s[52:55], s36 offen lds
  s_add_u32 s32, s32, 57344
  v_mfma_f32_32x32x16_bf16 v[48:63], v[116:119], v[96:99], v[48:63]
  v_mfma_f32_32x32x16_bf16 v[64:79], v[116:119], v[100:103], v[64:79]
  buffer_load_dwordx4 v[96:99], v13, s[8:11], s33 offen
  buffer_load_dwordx4 v[100:103], v13, s[8:11], s34 offen
  s_add_u32 s33, s33, 1024
  s_add_u32 s34, s34, 1024
  s_waitcnt vmcnt(6)
  ds_read_b64_tr_b16 v[112:113], v14 offset:0
  ds_read_b64_tr_b16 v[114:115], v14 offset:512
  ds_read_b64_tr_b16 v[116:117], v15 offset:0
  ds_read_b64_tr_b16 v[118:119], v15 offset:512
  s_waitcnt lgkmcnt(4)
  v_mfma_f32_32x32x16_bf16 v[16:31], v[120:123], v[104:107], v[16:31]
  v_mfma_f32_32x32x16_bf16 v[32:47], v[120:123], v[108:111], v[32:47]
  s_add_u32 m0, s31, 4096
  s_add_u32 s36, s32, 0
  buffer_load_dwordx4 v12, s[52:55], s36 offen lds
  s_add_u32 m0, s31, 5120
  s_add_u32 s36, s32, 28672
  buffer_load_dwordx4 v12, s[52:55], s36 offen lds
  s_add_u32 s32, s32, 57344
  v_mfma_f32_32x32x16_bf16 v[48:63], v[124:127], v[104:107], v[48:63]
  v_mfma_f32_32x32x16_bf16 v[64:79], v[124:127], v[108:111], v[64:79]
  buffer_load_dwordx4 v[104:107], v13, s[8:11], s33 offen
  buffer_load_dwordx4 v[108:111], v13, s[8:11], s34 offen
  s_add_u32 s33, s33, 1024
  s_add_u32 s34, s34, 1024
  s_waitcnt vmcnt(6)
  ds_read_b64_tr_b16 v[120:121], v14 offset:2048
  ds_read_b64_tr_b16 v[122:123], v14 offset:2560
  ds_read_b64_tr_b16 v[124:125], v15 offset:2048
  ds_read_b64_tr_b16 v[126:127], v15 offset:2560
  s_waitcnt lgkmcnt(4)
  v_mfma_f32_32x32x16_bf16 v[16:31], v[112:115], v[80:83], v[16:31]
  v_mfma_f32_32x32x16_bf16 v[32:47], v[112:115], v[84:87], v[32:47]
  s_add_u32 m0, s31, 0
  s_add_u32 s36, s32, 0
  buffer_load_dwordx4 v12, s[52:55], s36 offen lds
  s_add_u32 m0, s31, 1024
  s_add_u32 s36, s32, 28672
  buffer_load_dwordx4 v12, s[52:55], s36 offen lds
  s_add_u32 s32, s32, 57344
  v_mfma_f32_32x32x16_bf16 v[48:63], v[116:119], v[80:83], v[48:63]
  v_mfma_f32_32x32x16_bf16 v[64:79], v[116:119], v[84:87], v[64:79]
  buffer_load_dwordx4 v[80:83], v13, s[8:11], s33 offen
  buffer_load_dwordx4 v[84:87], v13, s[8:11], s34 offen
  s_add_u32 s33, s33, 1024
  s_add_u32 s34, s34, 1024
  s_waitcnt vmcnt(6)
  ds_read_b64_tr_b16 v[112:113], v14 offset:4096
  ds_read_b64_tr_b16 v[114:115], v14 offset:4608
  ds_read_b64_tr_b16 v[116:117], v15 offset:4096
  ds_read_b64_tr_b16 v[118:119], v15 offset:4608
  s_waitcnt lgkmcnt(4)
  v_mfma_f32_32x32x16_bf16 v[16:31], v[120:123], v[88:91], v[16:31]
  v_mfma_f32_32x32x16_bf16 v[32:47], v[120:123], v[92:95], v[32:47]
  s_add_u32 m0, s31, 2048
  s_add_u32 s36, s32, 0
  buffer_load_dwordx4 v12, s[52:55], s36 offen lds
  s_add_u32 m0, s31, 3072
  s_add_u32 s36, s32, 28672
  buffer_load_dwordx4 v12, s[52:55], s36 offen lds
  s_add_u32 s32, s32, 57344
  v_mfma_f32_32x32x16_bf16 v[48:63], v[124:127], v[88:91], v[48:63]
  v_mfma_f32_32x32x16_bf16 v[64:79], v[124:127], v[92:95], v[64:79]
  buffer_load_dwordx4 v[88:91], v13, s[8:11], s33 offen
  buffer_load_dwordx4 v[92:95], v13, s[8:11], s34 offen
  s_add_u32 s33, s33, 1024
  s_add_u32 s34, s34, 1024
  s_waitcnt vmcnt(6)
  ds_read_b64_tr_b16 v[120:121], v14 offset:0
  ds_read_b64_tr_b16 v[122:123], v14 offset:512
  ds_read_b64_tr_b16 v[124:125], v15 offset:0
  ds_read_b64_tr_b16 v[126:127], v15 offset:512
  s_waitcnt lgkmcnt(4)
  v_mfma_f32_32x32x16_bf16 v[16:31], v[112:115], v[96:99], v[16:31]
  v_mfma_f32_32x32x16_bf16 v[32:47], v[112:115], v[100:103], v[32:47]
  s_add_u32 m0, s31, 4096
  s_add_u32 s36, s32, 0
  buffer_load_dwordx4 v12, s[52:55], s36 offen lds
  s_add_u32 m0, s31, 5120
  s_add_u32 s36, s32, 28672
  buffer_load_dwordx4 v12, s[52:55], s36 offen lds
  s_add_u32 s32, s32, 57344
  v_mfma_f32_32x32x16_bf16 v[48:63], v[116:119], v[96:99], v[48:63]
  v_mfma_f32_32x32x16_bf16 v[64:79], v[116:119], v[100:103], v[64:79]
  buffer_load_dwordx4 v[96:99], v13, s[8:11], s33 offen
  buffer_load_dwordx4 v[100:103], v13, s[8:11], s34 offen
  s_add_u32 s33, s33, 1024
  s_add_u32 s34, s34, 1024
  s_waitcnt vmcnt(6)
  ds_read_b64_tr_b16 v[112:113], v14 offset:2048
  ds_read_b64_tr_b16 v[114:115], v14 offset:2560
  ds_read_b64_tr_b16 v[116:117], v15 offset:2048
  ds_read_b64_tr_b16 v[118:119], v15 offset:2560
  s_waitcnt lgkmcnt(4)
  v_mfma_f32_32x32x16_bf16 v[16:31], v[120:123], v[104:107], v[16:31]
  v_mfma_f32_32x32x16_bf16 v[32:47], v[120:123], v[108:111], v[32:47]
  s_add_u32 m0, s31, 0
  s_add_u32 s36, s32, 0
  buffer_load_dwordx4 v12, s[52:55], s36 offen lds
  s_add_u32 m0, s31, 1024
  s_add_u32 s36, s32, 28672
  buffer_load_dwordx4 v12, s[52:55], s36 offen lds
  s_add_u32 s32, s32, 57344
  v_mfma_f32_32x32x16_bf16 v[48:63], v[124:127], v[104:107], v[48:63]
  v_mfma_f32_32x32x16_bf16 v[64:79], v[124:127], v[108:111], v[64:79]
  buffer_load_dwordx4 v[104:107], v13, s[8:11], s33 offen
  buffer_load_dwordx4 v[108:111], v13, s[8:11], s34 offen
  s_add_u32 s33, s33, 1024
  s_add_u32 s34, s34, 1024
  s_waitcnt vmcnt(6)
  ds_read_b64_tr_b16 v[120:121], v14 offset:4096
  ds_read_b64_tr_b16 v[122:123], v14 offset:4608
  ds_read_b64_tr_b16 v[124:125], v15 offset:4096
  ds_read_b64_tr_b16 v[126:127], v15 offset:4608
  s_waitcnt lgkmcnt(4)
  v_mfma_f32_32x32x16_bf16 v[16:31], v[112:115], v[80:83], v[16:31]
  v_mfma_f32_32x32x16_bf16 v[32:47], v[112:115], v[84:87], v[32:47]
  s_add_u32 m0, s31, 2048
  s_add_u32 s36, s32, 0
  buffer_load_dwordx4 v12, s[52:55], s36 offen lds
  s_add_u32 m0, s31, 3072
  s_add_u32 s36, s32, 28672
  buffer_load_dwordx4 v12, s[52:55], s36 offen lds
  s_add_u32 s32, s32, 57344
  v_mfma_f32_32x32x16_bf16 v[48:63], v[116:119], v[80:83], v[48:63]
  v_mfma_f32_32x32x16_bf16 v[64:79], v[116:119], v[84:87], v[64:79]
  buffer_load_dwordx4 v[80:83], v13, s[8:11], s33 offen
  buffer_load_dwordx4 v[84:87], v13, s[8:11], s34 offen
  s_add_u32 s33, s33, 1024
  s_add_u32 s34, s34, 1024
  s_waitcnt vmcnt(6)
  ds_read_b64_tr_b16 v[112:113], v14 offset:0
  ds_read_b64_tr_b16 v[114:115], v14 offset:512
  ds_read_b64_tr_b16 v[116:117], v15 offset:0
  ds_read_b64_tr_b16 v[118:119], v15 offset:512
  s_waitcnt lgkmcnt(4)
  v_mfma_f32_32x32x16_bf16 v[16:31], v[120:123], v[88:91], v[16:31]
  v_mfma_f32_32x32x16_bf16 v[32:47], v[120:123], v[92:95], v[32:47]
  s_add_u32 m0, s31, 4096
  s_add_u32 s36, s32, 0
  buffer_load_dwordx4 v12, s[52:55], s36 offen lds
  s_add_u32 m0, s31, 5120
  s_add_u32 s36, s32, 28672
  buffer_load_dwordx4 v12, s[52:55], s36 offen lds
  s_add_u32 s32, s32, 57344
  v_mfma_f32_32x32x16_bf16 v[48:63], v[124:127], v[88:91], v[48:63]
  v_mfma_f32_32x32x16_bf16 v[64:79], v[124:127], v[92:95], v[64:79]
  buffer_load_dwordx4 v[88:91], v13, s[8:11], s33 offen
  buffer_load_dwordx4 v[92:95], v13, s[8:11], s34 offen
  s_add_u32 s33, s33, 1024
  s_add_u32 s34, s34, 1024
  s_waitcnt vmcnt(6)
  ds_read_b64_tr_b16 v[120:121], v14 offset:2048
  ds_read_b64_tr_b16 v[122:123], v14 offset:2560
  ds_read_b64_tr_b16 v[124:125], v15 offset:2048
  ds_read_b64_tr_b16 v[126:127], v15 offset:2560
  s_waitcnt lgkmcnt(4)
  v_mfma_f32_32x32x16_bf16 v[16:31], v[112:115], v[96:99], v[16:31]
  v_mfma_f32_32x32x16_bf16 v[32:47], v[112:115], v[100:103], v[32:47]
  s_add_u32 m0, s31, 0
  s_add_u32 s36, s32, 0
  buffer_load_dwordx4 v12, s[52:55], s36 offen lds
  s_add_u32 m0, s31, 1024
  s_add_u32 s36, s32, 28672
  buffer_load_dwordx4 v12, s[52:55], s36 offen lds
  s_add_u32 s32, s32, 57344
  v_mfma_f32_32x32x16_bf16 v[48:63], v[116:119], v[96:99], v[48:63]
  v_mfma_f32_32x32x16_bf16 v[64:79], v[116:119], v[100:103], v[64:79]
  buffer_load_dwordx4 v[96:99], v13, s[8:11], s33 offen
  buffer_load_dwordx4 v[100:103], v13, s[8:11], s34 offen
  s_add_u32 s33, s33, 1024
  s_add_u32 s34, s34, 1024
  s_waitcnt vmcnt(6)
  ds_read_b64_tr_b16 v[112:113], v14 offset:4096
  ds_read_b64_tr_b16 v[114:115], v14 offset:4608
  ds_read_b64_tr_b16 v[116:117], v15 offset:4096
  ds_read_b64_tr_b16 v[118:119], v15 offset:4608
  s_waitcnt lgkmcnt(4)
  v_mfma_f32_32x32x16_bf16 v[16:31], v[120:123], v[104:107], v[16:31]
  v_mfma_f32_32x32x16_bf16 v[32:47], v[120:123], v[108:111], v[32:47]
  s_add_u32 m0, s31, 2048
  s_add_u32 s36, s32, 0
  buffer_load_dwordx4 v12, s[52:55], s36 offen lds
  s_add_u32 m0, s31, 3072
  s_add_u32 s36, s32, 28672
  buffer_load_dwordx4 v12, s[52:55], s36 offen lds
  s_add_u32 s32, s32, 57344
  v_mfma_f32_32x32x16_bf16 v[48:63], v[124:127], v[104:107], v[48:63]
  v_mfma_f32_32x32x16_bf16 v[64:79], v[124:127], v[108:111], v[64:79]
  buffer_load_dwordx4 v[104:107], v13, s[8:11], s33 offen
  buffer_load_dwordx4 v[108:111], v13, s[8:11], s34 offen
  s_add_u32 s33, s33, 1024
  s_add_u32 s34, s34, 1024
  s_waitcnt vmcnt(6)
  ds_read_b64_tr_b16 v[120:121], v14 offset:0
  ds_read_b64_tr_b16 v[122:123], v14 offset:512
  ds_read_b64_tr_b16 v[124:125], v15 offset:0
  ds_read_b64_tr_b16 v[126:127], v15 offset:512
  s_waitcnt lgkmcnt(4)
  v_mfma_f32_32x32x16_bf16 v[16:31], v[112:115], v[80:83], v[16:31]
  v_mfma_f32_32x32x16_bf16 v[32:47], v[112:115], v[84:87], v[32:47]
  s_add_u32 m0, s31, 4096
  s_add_u32 s36, s32, 0
  buffer_load_dwordx4 v12, s[52:55], s36 offen lds
  s_add_u32 m0, s31, 5120
  s_add_u32 s36, s32, 28672
  buffer_load_dwordx4 v12, s[52:55], s36 offen lds
  s_add_u32 s32, s32, 57344
  v_mfma_f32_32x32x16_bf16 v[48:63], v[116:119], v[80:83], v[48:63]
  v_mfma_f32_32x32x16_bf16 v[64:79], v[116:119], v[84:87], v[64:79]
  buffer_load_dwordx4 v[80:83], v13, s[8:11], s33 offen
  buffer_load_dwordx4 v[84:87], v13, s[8:11], s34 offen
  s_add_u32 s33, s33, 1024
  s_add_u32 s34, s34, 1024
  s_waitcnt vmcnt(6)
  ds_read_b64_tr_b16 v[112:113], v14 offset:2048
  ds_read_b64_tr_b16 v[114:115], v14 offset:2560
  ds_read_b64_tr_b16 v[116:117], v15 offset:2048
  ds_read_b64_tr_b16 v[118:119], v15 offset:2560
  s_waitcnt lgkmcnt(4)
  v_mfma_f32_32x32x16_bf16 v[16:31], v[120:123], v[88:91], v[16:31]
  v_mfma_f32_32x32x16_bf16 v[32:47], v[120:123], v[92:95], v[32:47]
  s_add_u32 m0, s31, 0
  s_add_u32 s36, s32, 0
  buffer_load_dwordx4 v12, s[52:55], s36 offen lds
  s_add_u32 m0, s31, 1024
  s_add_u32 s36, s32, 28672
  buffer_load_dwordx4 v12, s[52:55], s36 offen lds
  s_add_u32 s32, s32, 57344
  v_mfma_f32_32x32x16_bf16 v[48:63], v[124:127], v[88:91], v[48:63]
  v_mfma_f32_32x32x16_bf16 v[64:79], v[124:127], v[92:95], v[64:79]
  buffer_load_dwordx4 v[88:91], v13, s[8:11], s33 offen
  buffer_load_dwordx4 v[92:95], v13, s[8:11], s34 offen
  s_add_u32 s33, s33, 1024
  s_add_u32 s34, s34, 1024
  s_waitcnt vmcnt(6)
  ds_read_b64_tr_b16 v[120:121], v14 offset:4096
  ds_read_b64_tr_b16 v[122:123], v14 offset:4608
  ds_read_b64_tr_b16 v[124:125], v15 offset:4096
  ds_read_b64_tr_b16 v[126:127], v15 offset:4608
  s_waitcnt lgkmcnt(4)
  v_mfma_f32_32x32x16_bf16 v[16:31], v[112:115], v[96:99], v[16:31]
  v_mfma_f32_32x32x16_bf16 v[32:47], v[112:115], v[100:103], v[32:47]
  s_add_u32 m0, s31, 2048
  s_add_u32 s36, s32, 0
  buffer_load_dwordx4 v12, s[52:55], s36 offen lds
  s_add_u32 m0, s31, 3072
  s_add_u32 s36, s32, 28672
  buffer_load_dwordx4 v12, s[52:55], s36 offen lds
  s_add_u32 s32, s32, 57344
  v_mfma_f32_32x32x16_bf16 v[48:63], v[116:119], v[96:99], v[48:63]
  v_mfma_f32_32x32x16_bf16 v[64:79], v[116:119], v[100:103], v[64:79]
  buffer_load_dwordx4 v[96:99], v13, s[8:11], s33 offen
  buffer_load_dwordx4 v[100:103], v13, s[8:11], s34 offen
  s_add_u32 s33, s33, 1024
  s_add_u32 s34, s34, 1024
  s_waitcnt vmcnt(6)
  ds_read_b64_tr_b16 v[112:113], v14 offset:0
  ds_read_b64_tr_b16 v[114:115], v14 offset:512
  ds_read_b64_tr_b16 v[116:117], v15 offset:0
  ds_read_b64_tr_b16 v[118:119], v15 offset:512
  s_waitcnt lgkmcnt(4)
  v_mfma_f32_32x32x16_bf16 v[16:31], v[120:123], v[104:107], v[16:31]
  v_mfma_f32_32x32x16_bf16 v[32:47], v[120:123], v[108:111], v[32:47]
  s_add_u32 m0, s31, 4096
  s_add_u32 s36, s32, 0
  buffer_load_dwordx4 v12, s[52:55], s36 offen lds
  s_add_u32 m0, s31, 5120
  s_add_u32 s36, s32, 28672
  buffer_load_dwordx4 v12, s[52:55], s36 offen lds
  s_add_u32 s32, s32, 57344
  v_mfma_f32_32x32x16_bf16 v[48:63], v[124:127], v[104:107], v[48:63]
  v_mfma_f32_32x32x16_bf16 v[64:79], v[124:127], v[108:111], v[64:79]
  buffer_load_dwordx4 v[104:107], v13, s[8:11], s33 offen
  buffer_load_dwordx4 v[108:111], v13, s[8:11], s34 offen
  s_add_u32 s33, s33, 1024
  s_add_u32 s34, s34, 1024
  s_waitcnt vmcnt(6)
  ds_read_b64_tr_b16 v[120:121], v14 offset:2048
  ds_read_b64_tr_b16 v[122:123], v14 offset:2560
  ds_read_b64_tr_b16 v[124:125], v15 offset:2048
  ds_read_b64_tr_b16 v[126:127], v15 offset:2560
  s_waitcnt lgkmcnt(4)
  v_mfma_f32_32x32x16_bf16 v[16:31], v[112:115], v[80:83], v[16:31]
  v_mfma_f32_32x32x16_bf16 v[32:47], v[112:115], v[84:87], v[32:47]
  s_add_u32 m0, s31, 0
  s_add_u32 s36, s32, 0
  buffer_load_dwordx4 v12, s[52:55], s36 offen lds
  s_add_u32 m0, s31, 1024
  s_add_u32 s36, s32, 28672
  buffer_load_dwordx4 v12, s[52:55], s36 offen lds
  s_add_u32 s32, s32, 57344
  v_mfma_f32_32x32x16_bf16 v[48:63], v[116:119], v[80:83], v[48:63]
  v_mfma_f32_32x32x16_bf16 v[64:79], v[116:119], v[84:87], v[64:79]
  buffer_load_dwordx4 v[80:83], v13, s[8:11], s33 offen
  buffer_load_dwordx4 v[84:87], v13, s[8:11], s34 offen
  s_add_u32 s33, s33, 1024
  s_add_u32 s34, s34, 1024
  s_waitcnt vmcnt(6)
  ds_read_b64_tr_b16 v[112:113], v14 offset:4096
  ds_read_b64_tr_b16 v[114:115], v14 offset:4608
  ds_read_b64_tr_b16 v[116:117], v15 offset:4096
  ds_read_b64_tr_b16 v[118:119], v15 offset:4608
  s_waitcnt lgkmcnt(4)
  v_mfma_f32_32x32x16_bf16 v[16:31], v[120:123], v[88:91], v[16:31]
  v_mfma_f32_32x32x16_bf16 v[32:47], v[120:123], v[92:95], v[32:47]
  s_add_u32 m0, s31, 2048
  s_add_u32 s36, s32, 0
  buffer_load_dwordx4 v12, s[52:55], s36 offen lds
  s_add_u32 m0, s31, 3072
  s_add_u32 s36, s32, 28672
  buffer_load_dwordx4 v12, s[52:55], s36 offen lds
  s_add_u32 s32, s32, 57344
  v_mfma_f32_32x32x16_bf16 v[48:63], v[124:127], v[88:91], v[48:63]
  v_mfma_f32_32x32x16_bf16 v[64:79], v[124:127], v[92:95], v[64:79]
  buffer_load_dwordx4 v[88:91], v13, s[8:11], s33 offen
  buffer_load_dwordx4 v[92:95], v13, s[8:11], s34 offen
  s_add_u32 s33, s33, 1024
  s_add_u32 s34, s34, 1024
  s_waitcnt vmcnt(6)
  ds_read_b64_tr_b16 v[120:121], v14 offset:0
  ds_read_b64_tr_b16 v[122:123], v14 offset:512
  ds_read_b64_tr_b16 v[124:125], v15 offset:0
  ds_read_b64_tr_b16 v[126:127], v15 offset:512
  s_waitcnt lgkmcnt(4)
  v_mfma_f32_32x32x16_bf16 v[16:31], v[112:115], v[96:99], v[16:31]
  v_mfma_f32_32x32x16_bf16 v[32:47], v[112:115], v[100:103], v[32:47]
  s_add_u32 m0, s31, 4096
  s_add_u32 s36, s32, 0
  buffer_load_dwordx4 v12, s[52:55], s36 offen lds
  s_add_u32 m0, s31, 5120
  s_add_u32 s36, s32, 28672
  buffer_load_dwordx4 v12, s[52:55], s36 offen lds
  s_add_u32 s32, s32, 57344
  v_mfma_f32_32x32x16_bf16 v[48:63], v[116:119], v[96:99], v[48:63]
  v_mfma_f32_32x32x16_bf16 v[64:79], v[116:119], v[100:103], v[64:79]
  buffer_load_dwordx4 v[96:99], v13, s[8:11], s33 offen
  buffer_load_dwordx4 v[100:103], v13, s[8:11], s34 offen
  s_add_u32 s33, s33, 1024
  s_add_u32 s34, s34, 1024
  s_waitcnt vmcnt(6)
  ds_read_b64_tr_b16 v[112:113], v14 offset:2048
  ds_read_b64_tr_b16 v[114:115], v14 offset:2560
  ds_read_b64_tr_b16 v[116:117], v15 offset:2048
  ds_read_b64_tr_b16 v[118:119], v15 offset:2560
  s_waitcnt lgkmcnt(4)
  v_mfma_f32_32x32x16_bf16 v[16:31], v[120:123], v[104:107], v[16:31]
  v_mfma_f32_32x32x16_bf16 v[32:47], v[120:123], v[108:111], v[32:47]
  s_add_u32 m0, s31, 0
  s_add_u32 s36, s32, 0
  buffer_load_dwordx4 v12, s[52:55], s36 offen lds
  s_add_u32 m0, s31, 1024
  s_add_u32 s36, s32, 28672
  buffer_load_dwordx4 v12, s[52:55], s36 offen lds
  s_add_u32 s32, s32, 57344
  v_mfma_f32_32x32x16_bf16 v[48:63], v[124:127], v[104:107], v[48:63]
  v_mfma_f32_32x32x16_bf16 v[64:79], v[124:127], v[108:111], v[64:79]
  buffer_load_dwordx4 v[104:107], v13, s[8:11], s33 offen
  buffer_load_dwordx4 v[108:111], v13, s[8:11], s34 offen
  s_add_u32 s33, s33, 1024
  s_add_u32 s34, s34, 1024
  s_waitcnt vmcnt(6)
  ds_read_b64_tr_b16 v[120:121], v14 offset:4096
  ds_read_b64_tr_b16 v[122:123], v14 offset:4608
  ds_read_b64_tr_b16 v[124:125], v15 offset:4096
  ds_read_b64_tr_b16 v[126:127], v15 offset:4608
  s_waitcnt lgkmcnt(4)
  v_mfma_f32_32x32x16_bf16 v[16:31], v[112:115], v[80:83], v[16:31]
  v_mfma_f32_32x32x16_bf16 v[32:47], v[112:115], v[84:87], v[32:47]
  s_add_u32 m0, s31, 2048
  s_add_u32 s36, s32, 0
  buffer_load_dwordx4 v12, s[52:55], s36 offen lds
  s_add_u32 m0, s31, 3072
  s_add_u32 s36, s32, 28672
  buffer_load_dwordx4 v12, s[52:55], s36 offen lds
  s_add_u32 s32, s32, 57344
  v_mfma_f32_32x32x16_bf16 v[48:63], v[116:119], v[80:83], v[48:63]
  v_mfma_f32_32x32x16_bf16 v[64:79], v[116:119], v[84:87], v[64:79]
  s_waitcnt vmcnt(4)
  ds_read_b64_tr_b16 v[112:113], v14 offset:0
  ds_read_b64_tr_b16 v[114:115], v14 offset:512
  ds_read_b64_tr_b16 v[116:117], v15 offset:0
  ds_read_b64_tr_b16 v[118:119], v15 offset:512
  s_waitcnt lgkmcnt(4)
  v_mfma_f32_32x32x16_bf16 v[16:31], v[120:123], v[88:91], v[16:31]
  v_mfma_f32_32x32x16_bf16 v[32:47], v[120:123], v[92:95], v[32:47]
  v_mfma_f32_32x32x16_bf16 v[48:63], v[124:127], v[88:91], v[48:63]
  v_mfma_f32_32x32x16_bf16 v[64:79], v[124:127], v[92:95], v[64:79]
  s_waitcnt vmcnt(0)
  ds_read_b64_tr_b16 v[120:121], v14 offset:2048
  ds_read_b64_tr_b16 v[122:123], v14 offset:2560
  ds_read_b64_tr_b16 v[124:125], v15 offset:2048
  ds_read_b64_tr_b16 v[126:127], v15 offset:2560
  s_waitcnt lgkmcnt(4)
  v_mfma_f32_32x32x16_bf16 v[16:31], v[112:115], v[96:99], v[16:31]
  v_mfma_f32_32x32x16_bf16 v[32:47], v[112:115], v[100:103], v[32:47]
  v_mfma_f32_32x32x16_bf16 v[48:63], v[116:119], v[96:99], v[48:63]
  v_mfma_f32_32x32x16_bf16 v[64:79], v[116:119], v[100:103], v[64:79]
  s_waitcnt lgkmcnt(0)
  v_mfma_f32_32x32x16_bf16 v[16:31], v[120:123], v[104:107], v[16:31]
  v_mfma_f32_32x32x16_bf16 v[32:47], v[120:123], v[108:111], v[32:47]
  v_mfma_f32_32x32x16_bf16 v[48:63], v[124:127], v[104:107], v[48:63]
  v_mfma_f32_32x32x16_bf16 v[64:79], v[124:127], v[108:111], v[64:79]
  s_setprio 3
  s_branch k2_kernel_nof1
k2_kernel_idlef1:
  s_waitcnt vmcnt(0)
  v_mov_b32 v2, 159748
  v_mov_b32 v3, 1
  s_mov_b64 s[26:27], exec
  s_mov_b64 exec, 1
  ds_add_u32 v2, v3
  s_mov_b64 exec, s[26:27]
  s_add_u32 m0, s23, 32768
  s_add_u32 s25, s21, s23
  s_add_u32 s25, s25, 32768
  buffer_load_dwordx4 v13, s[8:11], s25 offen lds
  s_add_u32 m0, s23, 100352
  s_add_u32 s25, s22, s23
  s_add_u32 s25, s25, 34816
  buffer_load_dwordx4 v13, s[8:11], s25 offen lds
  s_add_u32 m0, s23, 36864
  s_add_u32 s25, s21, s23
  s_add_u32 s25, s25, 36864
  buffer_load_dwordx4 v13, s[8:11], s25 offen lds
  s_add_u32 m0, s23, 104448
  s_add_u32 s25, s22, s23
  s_add_u32 s25, s25, 38912
  buffer_load_dwordx4 v13, s[8:11], s25 offen lds
  s_add_u32 m0, s23, 40960
  s_add_u32 s25, s21, s23
  s_add_u32 s25, s25, 40960
  buffer_load_dwordx4 v13, s[8:11], s25 offen lds
  s_add_u32 m0, s23, 108544
  s_add_u32 s25, s22, s23
  s_add_u32 s25, s25, 43008
  buffer_load_dwordx4 v13, s[8:11], s25 offen lds
  s_add_u32 m0, s23, 45056
  s_add_u32 s25, s21, s23
  s_add_u32 s25, s25, 45056
  buffer_load_dwordx4 v13, s[8:11], s25 offen lds
  s_add_u32 m0, s23, 112640
  s_add_u32 s25, s22, s23
  s_add_u32 s25, s25, 47104
  buffer_load_dwordx4 v13, s[8:11], s25 offen lds
  s_add_u32 m0, s23, 49152
  s_add_u32 s25, s21, s23
  s_add_u32 s25, s25, 49152
  buffer_load_dwordx4 v13, s[8:11], s25 offen lds
  s_add_u32 m0, s23, 116736
  s_add_u32 s25, s22, s23
  s_add_u32 s25, s25, 51200
  buffer_load_dwordx4 v13, s[8:11], s25 offen lds
  s_add_u32 m0, s23, 53248
  s_add_u32 s25, s21, s23
  s_add_u32 s25, s25, 53248
  buffer_load_dwordx4 v13, s[8:11], s25 offen lds
  s_add_u32 m0, s23, 120832
  s_add_u32 s25, s22, s23
  s_add_u32 s25, s25, 55296
  buffer_load_dwordx4 v13, s[8:11], s25 offen lds
  s_add_u32 m0, s23, 57344
  s_add_u32 s25, s21, s23
  s_add_u32 s25, s25, 57344
  buffer_load_dwordx4 v13, s[8:11], s25 offen lds
  s_add_u32 m0, s23, 124928
  s_add_u32 s25, s22, s23
  s_add_u32 s25, s25, 59392
  buffer_load_dwordx4 v13, s[8:11], s25 offen lds
  s_add_u32 m0, s23, 61440
  s_add_u32 s25, s21, s23
  s_add_u32 s25, s25, 61440
  buffer_load_dwordx4 v13, s[8:11], s25 offen lds
  s_add_u32 m0, s23, 129024
  s_add_u32 s25, s22, s23
  s_add_u32 s25, s25, 63488
  buffer_load_dwordx4 v13, s[8:11], s25 offen lds
  s_add_u32 m0, s24, 133120
  s_add_u32 s25, s22, s24
  s_add_u32 s25, s25, 67584
  buffer_load_dwordx4 v13, s[8:11], s25 offen lds
  s_waitcnt vmcnt(0)
  v_mov_b32 v2, 159756
  v_mov_b32 v3, 1
  s_mov_b64 s[26:27], exec
  s_mov_b64 exec, 1
  ds_add_u32 v2, v3
  s_mov_b64 exec, s[26:27]
k2_kernel_nof1:
  s_lshr_b32 s48, s30, 1
  s_and_b32 s49, s30, 1
  s_mov_b32 s52, s64
  s_mov_b32 s53, s65
  s_mov_b32 s54, 1835008
  s_mov_b32 s55, 0x20000
  s_mov_b32 s56, s66
  s_mov_b32 s57, s67
  s_mov_b32 s58, 1024
  s_mov_b32 s59, 0x20000
  v_lshrrev_b32 v4, 3, v1
  v_and_b32 v5, 7, v1
  v_bfe_u32 v6, v1, 4, 1
  v_lshlrev_b32 v6, 2, v6
  v_xor_b32 v5, v5, v6
  v_lshlrev_b32 v5, 4, v5
  v_mul_u32_u24 v4, 1024, v4
  v_add_u32 v12, v4, v5
  v_lshrrev_b32 v4, 5, v1
  v_lshlrev_b32 v4, 2, v4
  v_bfe_u32 v5, v1, 2, 2
  v_add_u32 v4, v4, v5
  v_lshlrev_b32 v4, 7, v4
  v_lshrrev_b32 v5, 1, v5
  v_xor_b32 v5, s48, v5
  v_lshl_add_u32 v4, v5, 6, v4
  v_bfe_u32 v5, v1, 4, 1
  v_lshl_add_u32 v4, v5, 5, v4
  v_and_b32 v5, 3, v1
  v_lshl_add_u32 v4, v5, 3, v4
  v_add_u32 v14, s31, v4
  v_xor_b32 v15, 64, v14
  v_lshlrev_b32 v4, 4, v1
  v_add_u32 v11, s31, v4
  s_mul_i32 s32, s30, 458752
  s_lshl_b32 s46, s13, 7
  s_add_u32 s32, s32, s46
  s_add_u32 m0, s31, 0
  s_add_u32 s36, s32, 0
  buffer_load_dwordx4 v12, s[52:55], s36 offen lds
  s_add_u32 m0, s31, 1024
  s_add_u32 s36, s32, 8192
  buffer_load_dwordx4 v12, s[52:55], s36 offen lds
  s_add_u32 s32, s32, 16384
  s_add_u32 m0, s31, 2048
  s_add_u32 s36, s32, 0
  buffer_load_dwordx4 v12, s[52:55], s36 offen lds
  s_add_u32 m0, s31, 3072
  s_add_u32 s36, s32, 8192
  buffer_load_dwordx4 v12, s[52:55], s36 offen lds
  s_add_u32 s32, s32, 16384
  s_add_u32 m0, s31, 4096
  s_add_u32 s36, s32, 0
  buffer_load_dwordx4 v12, s[52:55], s36 offen lds
  s_add_u32 m0, s31, 5120
  s_add_u32 s36, s32, 8192
  buffer_load_dwordx4 v12, s[52:55], s36 offen lds
  s_add_u32 s32, s32, 16384
  v_lshrrev_b32 v4, 5, v1
  v_lshlrev_b32 v4, 3, v4
  s_lshl_b32 s46, s13, 7
  s_lshl_b32 s47, s48, 6
  s_add_u32 s46, s46, s47
  buffer_load_dwordx2 v[112:113], v4, s[56:59], s46 offen offset:0
  buffer_load_dwordx2 v[114:115], v4, s[56:59], s46 offen offset:16
  buffer_load_dwordx2 v[116:117], v4, s[56:59], s46 offen offset:32
  buffer_load_dwordx2 v[118:119], v4, s[56:59], s46 offen offset:48
  s_cmp_eq_u32 s68, 0
  s_cbranch_scc1 k2_kernel_sig2
  s_nop 7
  v_max_f32 v16, 0, v16
  v_max_f32 v17, 0, v17
  v_max_f32 v18, 0, v18
  v_max_f32 v19, 0, v19
  v_max_f32 v20, 0, v20
  v_max_f32 v21, 0, v21
  v_max_f32 v22, 0, v22
  v_max_f32 v23, 0, v23
  v_max_f32 v24, 0, v24
  v_max_f32 v25, 0, v25
  v_max_f32 v26, 0, v26
  v_max_f32 v27, 0, v27
  v_max_f32 v28, 0, v28
  v_max_f32 v29, 0, v29
  v_max_f32 v30, 0, v30
  v_max_f32 v31, 0, v31
  v_mul_f32 v16, v16, v16
  v_mul_f32 v17, v17, v17
  v_mul_f32 v18, v18, v18
  v_mul_f32 v19, v19, v19
  v_mul_f32 v20, v20, v20
  v_mul_f32 v21, v21, v21
  v_mul_f32 v22, v22, v22
  v_mul_f32 v23, v23, v23
  v_mul_f32 v24, v24, v24
  v_mul_f32 v25, v25, v25
  v_mul_f32 v26, v26, v26
  v_mul_f32 v27, v27, v27
  v_mul_f32 v28, v28, v28
  v_mul_f32 v29, v29, v29
  v_mul_f32 v30, v30, v30
  v_mul_f32 v31, v31, v31
  v_cvt_pk_bf16_f32 v16, v16, v17
  v_cvt_pk_bf16_f32 v17, v18, v19
  v_cvt_pk_bf16_f32 v18, v20, v21
  v_cvt_pk_bf16_f32 v19, v22, v23
  v_cvt_pk_bf16_f32 v20, v24, v25
  v_cvt_pk_bf16_f32 v21, v26, v27
  v_cvt_pk_bf16_f32 v22, v28, v29
  v_cvt_pk_bf16_f32 v23, v30, v31
  v_max_f32 v32, 0, v32
  v_max_f32 v33, 0, v33
  v_max_f32 v34, 0, v34
  v_max_f32 v35, 0, v35
  v_max_f32 v36, 0, v36
  v_max_f32 v37, 0, v37
  v_max_f32 v38, 0, v38
  v_max_f32 v39, 0, v39
  v_max_f32 v40, 0, v40
  v_max_f32 v41, 0, v41
  v_max_f32 v42, 0, v42
  v_max_f32 v43, 0, v43
  v_max_f32 v44, 0, v44
  v_max_f32 v45, 0, v45
  v_max_f32 v46, 0, v46
  v_max_f32 v47, 0, v47
  v_mul_f32 v32, v32, v32
  v_mul_f32 v33, v33, v33
  v_mul_f32 v34, v34, v34
  v_mul_f32 v35, v35, v35
  v_mul_f32 v36, v36, v36
  v_mul_f32 v37, v37, v37
  v_mul_f32 v38, v38, v38
  v_mul_f32 v39, v39, v39
  v_mul_f32 v40, v40, v40
  v_mul_f32 v41, v41, v41
  v_mul_f32 v42, v42, v42
  v_mul_f32 v43, v43, v43
  v_mul_f32 v44, v44, v44
  v_mul_f32 v45, v45, v45
  v_mul_f32 v46, v46, v46
  v_mul_f32 v47, v47, v47
  v_cvt_pk_bf16_f32 v32, v32, v33
  v_cvt_pk_bf16_f32 v33, v34, v35
  v_cvt_pk_bf16_f32 v34, v36, v37
  v_cvt_pk_bf16_f32 v35, v38, v39
  v_cvt_pk_bf16_f32 v36, v40, v41
  v_cvt_pk_bf16_f32 v37, v42, v43
  v_cvt_pk_bf16_f32 v38, v44, v45
  v_cvt_pk_bf16_f32 v39, v46, v47
  v_max_f32 v48, 0, v48
  v_max_f32 v49, 0, v49
  v_max_f32 v50, 0, v50
  v_max_f32 v51, 0, v51
  v_max_f32 v52, 0, v52
  v_max_f32 v53, 0, v53
  v_max_f32 v54, 0, v54
  v_max_f32 v55, 0, v55
  v_max_f32 v56, 0, v56
  v_max_f32 v57, 0, v57
  v_max_f32 v58, 0, v58
  v_max_f32 v59, 0, v59
  v_max_f32 v60, 0, v60
  v_max_f32 v61, 0, v61
  v_max_f32 v62, 0, v62
  v_max_f32 v63, 0, v63
  v_mul_f32 v48, v48, v48
  v_mul_f32 v49, v49, v49
  v_mul_f32 v50, v50, v50
  v_mul_f32 v51, v51, v51
  v_mul_f32 v52, v52, v52
  v_mul_f32 v53, v53, v53
  v_mul_f32 v54, v54, v54
  v_mul_f32 v55, v55, v55
  v_mul_f32 v56, v56, v56
  v_mul_f32 v57, v57, v57
  v_mul_f32 v58, v58, v58
  v_mul_f32 v59, v59, v59
  v_mul_f32 v60, v60, v60
  v_mul_f32 v61, v61, v61
  v_mul_f32 v62, v62, v62
  v_mul_f32 v63, v63, v63
  v_cvt_pk_bf16_f32 v48, v48, v49
  v_cvt_pk_bf16_f32 v49, v50, v51
  v_cvt_pk_bf16_f32 v50, v52, v53
  v_cvt_pk_bf16_f32 v51, v54, v55
  v_cvt_pk_bf16_f32 v52, v56, v57
  v_cvt_pk_bf16_f32 v53, v58, v59
  v_cvt_pk_bf16_f32 v54, v60, v61
  v_cvt_pk_bf16_f32 v55, v62, v63
  v_max_f32 v64, 0, v64
  v_max_f32 v65, 0, v65
  v_max_f32 v66, 0, v66
  v_max_f32 v67, 0, v67
  v_max_f32 v68, 0, v68
  v_max_f32 v69, 0, v69
  v_max_f32 v70, 0, v70
  v_max_f32 v71, 0, v71
  v_max_f32 v72, 0, v72
  v_max_f32 v73, 0, v73
  v_max_f32 v74, 0, v74
  v_max_f32 v75, 0, v75
  v_max_f32 v76, 0, v76
  v_max_f32 v77, 0, v77
  v_max_f32 v78, 0, v78
  v_max_f32 v79, 0, v79
  v_mul_f32 v64, v64, v64
  v_mul_f32 v65, v65, v65
  v_mul_f32 v66, v66, v66
  v_mul_f32 v67, v67, v67
  v_mul_f32 v68, v68, v68
  v_mul_f32 v69, v69, v69
  v_mul_f32 v70, v70, v70
  v_mul_f32 v71, v71, v71
  v_mul_f32 v72, v72, v72
  v_mul_f32 v73, v73, v73
  v_mul_f32 v74, v74, v74
  v_mul_f32 v75, v75, v75
  v_mul_f32 v76, v76, v76
  v_mul_f32 v77, v77, v77
  v_mul_f32 v78, v78, v78
  v_mul_f32 v79, v79, v79
  v_cvt_pk_bf16_f32 v64, v64, v65
  v_cvt_pk_bf16_f32 v65, v66, v67
  v_cvt_pk_bf16_f32 v66, v68, v69
  v_cvt_pk_bf16_f32 v67, v70, v71
  v_cvt_pk_bf16_f32 v68, v72, v73
  v_cvt_pk_bf16_f32 v69, v74, v75
  v_cvt_pk_bf16_f32 v70, v76, v77
  v_cvt_pk_bf16_f32 v71, v78, v79
k2_kernel_sig2:
  s_cmp_eq_u32 s68, 0
  s_cbranch_scc1 k2_kernel_noepi
  s_lshl_b32 s46, s12, 1
  s_mul_i32 s46, s46, 112
  s_lshl_b32 s47, s44, 2
  s_add_u32 s46, s46, s47
  s_lshl_b32 s46, s46, 10
  s_add_u32 s46, s46, 8912896
  buffer_store_dwordx4 v[16:19], v13, s[8:11], s46 offen offset:0 sc1
  buffer_store_dwordx4 v[20:23], v13, s[8:11], s46 offen offset:1024 sc1
  s_lshl_b32 s46, s12, 1
  s_add_u32 s46, s46, 1
  s_mul_i32 s46, s46, 112
  s_lshl_b32 s47, s44, 2
  s_add_u32 s46, s46, s47
  s_lshl_b32 s46, s46, 10
  s_add_u32 s46, s46, 8912896
  buffer_store_dwordx4 v[32:35], v13, s[8:11], s46 offen offset:0 sc1
  buffer_store_dwordx4 v[36:39], v13, s[8:11], s46 offen offset:1024 sc1
  s_lshl_b32 s46, s12, 1
  s_mul_i32 s46, s46, 112
  s_lshl_b32 s47, s44, 2
  s_add_u32 s46, s46, s47
  s_add_u32 s46, s46, 2
  s_lshl_b32 s46, s46, 10
  s_add_u32 s46, s46, 8912896
  buffer_store_dwordx4 v[48:51], v13, s[8:11], s46 offen offset:0 sc1
  buffer_store_dwordx4 v[52:55], v13, s[8:11], s46 offen offset:1024 sc1
  s_lshl_b32 s46, s12, 1
  s_add_u32 s46, s46, 1
  s_mul_i32 s46, s46, 112
  s_lshl_b32 s47, s44, 2
  s_add_u32 s46, s46, s47
  s_add_u32 s46, s46, 2
  s_lshl_b32 s46, s46, 10
  s_add_u32 s46, s46, 8912896
  buffer_store_dwordx4 v[64:67], v13, s[8:11], s46 offen offset:0 sc1
  buffer_store_dwordx4 v[68:71], v13, s[8:11], s46 offen offset:1024 sc1
  s_waitcnt vmcnt(0)
  v_mov_b32 v4, 1
  v_lshlrev_b32 v5, 16, v1
  s_mov_b64 s[40:41], exec
  s_mov_b64 exec, 0xff
  buffer_store_dword v4, v5, s[8:11], s45 offen sc1
  s_mov_b64 exec, s[40:41]
k2_kernel_noepi:
  s_xor_b32 s46, s49, 0
  s_lshl_b32 s47, s12, 1
  s_add_u32 s46, s46, s47
  s_mul_i32 s46, s46, 112
  s_mul_i32 s47, s30, 28
  s_add_u32 s46, s46, s47
  s_lshl_b32 s46, s46, 10
  s_add_u32 s33, s46, 8912896
  s_xor_b32 s46, s49, 1
  s_lshl_b32 s47, s12, 1
  s_add_u32 s46, s46, s47
  s_mul_i32 s46, s46, 112
  s_mul_i32 s47, s30, 28
  s_add_u32 s46, s46, s47
  s_lshl_b32 s46, s46, 10
  s_add_u32 s34, s46, 8912896
  s_waitcnt vmcnt(0)
  v_lshlrev_b32 v16, 16, v112
  v_and_b32 v17, 0xffff0000, v112
  v_lshlrev_b32 v18, 16, v113
  v_and_b32 v19, 0xffff0000, v113
  v_lshlrev_b32 v20, 16, v114
  v_and_b32 v21, 0xffff0000, v114
  v_lshlrev_b32 v22, 16, v115
  v_and_b32 v23, 0xffff0000, v115
  v_lshlrev_b32 v24, 16, v116
  v_and_b32 v25, 0xffff0000, v116
  v_lshlrev_b32 v26, 16, v117
  v_and_b32 v27, 0xffff0000, v117
  v_lshlrev_b32 v28, 16, v118
  v_and_b32 v29, 0xffff0000, v118
  v_lshlrev_b32 v30, 16, v119
  v_and_b32 v31, 0xffff0000, v119
  v_and_b32 v4, 7, v1
  v_cmp_eq_u32 s[42:43], 7, v4
  v_lshlrev_b32 v4, 2, v4
  s_lshl_b32 s46, s2, 11
  s_lshl_b32 s47, s30, 7
  s_add_u32 s46, s46, s47
  s_add_u32 s46, s46, 20972160
  s_mov_b32 s47, 0
k2_kernel_poll:
  buffer_load_dword v5, v4, s[8:11], s46 offen sc1
  s_waitcnt vmcnt(0)
  v_cmp_eq_u32 vcc, 1, v5
  s_add_u32 s47, s47, 1
  s_nop 0
  s_or_b64 vcc, vcc, s[42:43]
  s_cmp_eq_u64 vcc, -1
  s_cbranch_scc1 k2_kernel_polld
  s_cmp_ge_u32 s47, 0x4000
  s_cbranch_scc1 k2_kernel_polld
  s_branch k2_kernel_poll
k2_kernel_polld:
  buffer_load_dwordx4 v[80:83], v13, s[8:11], s33 offen sc1
  buffer_load_dwordx4 v[84:87], v13, s[8:11], s34 offen sc1
  s_add_u32 s33, s33, 1024
  s_add_u32 s34, s34, 1024
  buffer_load_dwordx4 v[88:91], v13, s[8:11], s33 offen sc1
  buffer_load_dwordx4 v[92:95], v13, s[8:11], s34 offen sc1
  s_add_u32 s33, s33, 1024
  s_add_u32 s34, s34, 1024
  buffer_load_dwordx4 v[96:99], v13, s[8:11], s33 offen sc1
  buffer_load_dwordx4 v[100:103], v13, s[8:11], s34 offen sc1
  s_add_u32 s33, s33, 1024
  s_add_u32 s34, s34, 1024
  buffer_load_dwordx4 v[104:107], v13, s[8:11], s33 offen sc1
  buffer_load_dwordx4 v[108:111], v13, s[8:11], s34 offen sc1
  s_add_u32 s33, s33, 1024
  s_add_u32 s34, s34, 1024
  s_setprio 0
  s_waitcnt vmcnt(6)
  ds_read_b64_tr_b16 v[112:113], v14 offset:0
  ds_read_b64_tr_b16 v[114:115], v14 offset:1024
  ds_read_b64_tr_b16 v[116:117], v15 offset:0
  ds_read_b64_tr_b16 v[118:119], v15 offset:1024
  ds_read_b64_tr_b16 v[120:121], v14 offset:2048
  ds_read_b64_tr_b16 v[122:123], v14 offset:3072
  ds_read_b64_tr_b16 v[124:125], v15 offset:2048
  ds_read_b64_tr_b16 v[126:127], v15 offset:3072
  s_waitcnt lgkmcnt(4)
  v_mfma_f32_32x32x16_bf16 v[32:47], v[112:115], v[84:87], 0
  v_mfma_f32_32x32x16_bf16 v[16:31], v[112:115], v[80:83], v[16:31]
  s_add_u32 m0, s31, 0
  s_add_u32 s36, s32, 0
  buffer_load_dwordx4 v12, s[52:55], s36 offen lds
  s_add_u32 m0, s31, 1024
  s_add_u32 s36, s32, 8192
  buffer_load_dwordx4 v12, s[52:55], s36 offen lds
  s_add_u32 s32, s32, 16384
  v_mfma_f32_32x32x16_bf16 v[64:79], v[116:119], v[84:87], 0
  v_mfma_f32_32x32x16_bf16 v[48:63], v[116:119], v[80:83], 0
  buffer_load_dwordx4 v[80:83], v13, s[8:11], s33 offen sc1
  buffer_load_dwordx4 v[84:87], v13, s[8:11], s34 offen sc1
  s_add_u32 s33, s33, 1024
  s_add_u32 s34, s34, 1024
  s_waitcnt vmcnt(8)
  ds_read_b64_tr_b16 v[112:113], v14 offset:4096
  ds_read_b64_tr_b16 v[114:115], v14 offset:5120
  ds_read_b64_tr_b16 v[116:117], v15 offset:4096
  ds_read_b64_tr_b16 v[118:119], v15 offset:5120
  s_waitcnt lgkmcnt(4)
  v_mfma_f32_32x32x16_bf16 v[16:31], v[120:123], v[88:91], v[16:31]
  v_mfma_f32_32x32x16_bf16 v[32:47], v[120:123], v[92:95], v[32:47]
  s_add_u32 m0, s31, 2048
  s_add_u32 s36, s32, 0
  buffer_load_dwordx4 v12, s[52:55], s36 offen lds
  s_add_u32 m0, s31, 3072
  s_add_u32 s36, s32, 8192
  buffer_load_dwordx4 v12, s[52:55], s36 offen lds
  s_add_u32 s32, s32, 16384
  v_mfma_f32_32x32x16_bf16 v[48:63], v[124:127], v[88:91], v[48:63]
  v_mfma_f32_32x32x16_bf16 v[64:79], v[124:127], v[92:95], v[64:79]
  buffer_load_dwordx4 v[88:91], v13, s[8:11], s33 offen sc1
  buffer_load_dwordx4 v[92:95], v13, s[8:11], s34 offen sc1
  s_add_u32 s33, s33, 1024
  s_add_u32 s34, s34, 1024
  s_waitcnt vmcnt(6)
  ds_read_b64_tr_b16 v[120:121], v14 offset:0
  ds_read_b64_tr_b16 v[122:123], v14 offset:1024
  ds_read_b64_tr_b16 v[124:125], v15 offset:0
  ds_read_b64_tr_b16 v[126:127], v15 offset:1024
  s_waitcnt lgkmcnt(4)
  v_mfma_f32_32x32x16_bf16 v[16:31], v[112:115], v[96:99], v[16:31]
  v_mfma_f32_32x32x16_bf16 v[32:47], v[112:115], v[100:103], v[32:47]
  s_add_u32 m0, s31, 4096
  s_add_u32 s36, s32, 0
  buffer_load_dwordx4 v12, s[52:55], s36 offen lds
  s_add_u32 m0, s31, 5120
  s_add_u32 s36, s32, 8192
  buffer_load_dwordx4 v12, s[52:55], s36 offen lds
  s_add_u32 s32, s32, 16384
  v_mfma_f32_32x32x16_bf16 v[48:63], v[116:119], v[96:99], v[48:63]
  v_mfma_f32_32x32x16_bf16 v[64:79], v[116:119], v[100:103], v[64:79]
  buffer_load_dwordx4 v[96:99], v13, s[8:11], s33 offen sc1
  buffer_load_dwordx4 v[100:103], v13, s[8:11], s34 offen sc1
  s_add_u32 s33, s33, 1024
  s_add_u32 s34, s34, 1024
  s_waitcnt vmcnt(6)
  ds_read_b64_tr_b16 v[112:113], v14 offset:2048
  ds_read_b64_tr_b16 v[114:115], v14 offset:3072
  ds_read_b64_tr_b16 v[116:117], v15 offset:2048
  ds_read_b64_tr_b16 v[118:119], v15 offset:3072
  s_waitcnt lgkmcnt(4)
  v_mfma_f32_32x32x16_bf16 v[16:31], v[120:123], v[104:107], v[16:31]
  v_mfma_f32_32x32x16_bf16 v[32:47], v[120:123], v[108:111], v[32:47]
  s_add_u32 m0, s31, 0
  s_add_u32 s36, s32, 0
  buffer_load_dwordx4 v12, s[52:55], s36 offen lds
  s_add_u32 m0, s31, 1024
  s_add_u32 s36, s32, 8192
  buffer_load_dwordx4 v12, s[52:55], s36 offen lds
  s_add_u32 s32, s32, 16384
  v_mfma_f32_32x32x16_bf16 v[48:63], v[124:127], v[104:107], v[48:63]
  v_mfma_f32_32x32x16_bf16 v[64:79], v[124:127], v[108:111], v[64:79]
  buffer_load_dwordx4 v[104:107], v13, s[8:11], s33 offen sc1
  buffer_load_dwordx4 v[108:111], v13, s[8:11], s34 offen sc1
  s_add_u32 s33, s33, 1024
  s_add_u32 s34, s34, 1024
  s_waitcnt vmcnt(6)
  ds_read_b64_tr_b16 v[120:121], v14 offset:4096
  ds_read_b64_tr_b16 v[122:123], v14 offset:5120
  ds_read_b64_tr_b16 v[124:125], v15 offset:4096
  ds_read_b64_tr_b16 v[126:127], v15 offset:5120
  s_waitcnt lgkmcnt(4)
  v_mfma_f32_32x32x16_bf16 v[16:31], v[112:115], v[80:83], v[16:31]
  v_mfma_f32_32x32x16_bf16 v[32:47], v[112:115], v[84:87], v[32:47]
  s_add_u32 m0, s31, 2048
  s_add_u32 s36, s32, 0
  buffer_load_dwordx4 v12, s[52:55], s36 offen lds
  s_add_u32 m0, s31, 3072
  s_add_u32 s36, s32, 8192
  buffer_load_dwordx4 v12, s[52:55], s36 offen lds
  s_add_u32 s32, s32, 16384
  v_mfma_f32_32x32x16_bf16 v[48:63], v[116:119], v[80:83], v[48:63]
  v_mfma_f32_32x32x16_bf16 v[64:79], v[116:119], v[84:87], v[64:79]
  buffer_load_dwordx4 v[80:83], v13, s[8:11], s33 offen sc1
  buffer_load_dwordx4 v[84:87], v13, s[8:11], s34 offen sc1
  s_add_u32 s33, s33, 1024
  s_add_u32 s34, s34, 1024
  s_waitcnt vmcnt(6)
  ds_read_b64_tr_b16 v[112:113], v14 offset:0
  ds_read_b64_tr_b16 v[114:115], v14 offset:1024
  ds_read_b64_tr_b16 v[116:117], v15 offset:0
  ds_read_b64_tr_b16 v[118:119], v15 offset:1024
  s_waitcnt lgkmcnt(4)
  v_mfma_f32_32x32x16_bf16 v[16:31], v[120:123], v[88:91], v[16:31]
  v_mfma_f32_32x32x16_bf16 v[32:47], v[120:123], v[92:95], v[32:47]
  s_add_u32 m0, s31, 4096
  s_add_u32 s36, s32, 0
  buffer_load_dwordx4 v12, s[52:55], s36 offen lds
  s_add_u32 m0, s31, 5120
  s_add_u32 s36, s32, 8192
  buffer_load_dwordx4 v12, s[52:55], s36 offen lds
  s_add_u32 s32, s32, 16384
  v_mfma_f32_32x32x16_bf16 v[48:63], v[124:127], v[88:91], v[48:63]
  v_mfma_f32_32x32x16_bf16 v[64:79], v[124:127], v[92:95], v[64:79]
  buffer_load_dwordx4 v[88:91], v13, s[8:11], s33 offen sc1
  buffer_load_dwordx4 v[92:95], v13, s[8:11], s34 offen sc1
  s_add_u32 s33, s33, 1024
  s_add_u32 s34, s34, 1024
  s_waitcnt vmcnt(6)
  ds_read_b64_tr_b16 v[120:121], v14 offset:2048
  ds_read_b64_tr_b16 v[122:123], v14 offset:3072
  ds_read_b64_tr_b16 v[124:125], v15 offset:2048
  ds_read_b64_tr_b16 v[126:127], v15 offset:3072
  s_waitcnt lgkmcnt(4)
  v_mfma_f32_32x32x16_bf16 v[16:31], v[112:115], v[96:99], v[16:31]
  v_mfma_f32_32x32x16_bf16 v[32:47], v[112:115], v[100:103], v[32:47]
  s_add_u32 m0, s31, 0
  s_add_u32 s36, s32, 0
  buffer_load_dwordx4 v12, s[52:55], s36 offen lds
  s_add_u32 m0, s31, 1024
  s_add_u32 s36, s32, 8192
  buffer_load_dwordx4 v12, s[52:55], s36 offen lds
  s_add_u32 s32, s32, 16384
  v_mfma_f32_32x32x16_bf16 v[48:63], v[116:119], v[96:99], v[48:63]
  v_mfma_f32_32x32x16_bf16 v[64:79], v[116:119], v[100:103], v[64:79]
  buffer_load_dwordx4 v[96:99], v13, s[8:11], s33 offen sc1
  buffer_load_dwordx4 v[100:103], v13, s[8:11], s34 offen sc1
  s_add_u32 s33, s33, 1024
  s_add_u32 s34, s34, 1024
  s_waitcnt vmcnt(6)
  ds_read_b64_tr_b16 v[112:113], v14 offset:4096
  ds_read_b64_tr_b16 v[114:115], v14 offset:5120
  ds_read_b64_tr_b16 v[116:117], v15 offset:4096
  ds_read_b64_tr_b16 v[118:119], v15 offset:5120
  s_waitcnt lgkmcnt(4)
  v_mfma_f32_32x32x16_bf16 v[16:31], v[120:123], v[104:107], v[16:31]
  v_mfma_f32_32x32x16_bf16 v[32:47], v[120:123], v[108:111], v[32:47]
  s_add_u32 m0, s31, 2048
  s_add_u32 s36, s32, 0
  buffer_load_dwordx4 v12, s[52:55], s36 offen lds
  s_add_u32 m0, s31, 3072
  s_add_u32 s36, s32, 8192
  buffer_load_dwordx4 v12, s[52:55], s36 offen lds
  s_add_u32 s32, s32, 16384
  v_mfma_f32_32x32x16_bf16 v[48:63], v[124:127], v[104:107], v[48:63]
  v_mfma_f32_32x32x16_bf16 v[64:79], v[124:127], v[108:111], v[64:79]
  buffer_load_dwordx4 v[104:107], v13, s[8:11], s33 offen sc1
  buffer_load_dwordx4 v[108:111], v13, s[8:11], s34 offen sc1
  s_add_u32 s33, s33, 1024
  s_add_u32 s34, s34, 1024
  s_waitcnt vmcnt(6)
  ds_read_b64_tr_b16 v[120:121], v14 offset:0
  ds_read_b64_tr_b16 v[122:123], v14 offset:1024
  ds_read_b64_tr_b16 v[124:125], v15 offset:0
  ds_read_b64_tr_b16 v[126:127], v15 offset:1024
  s_waitcnt lgkmcnt(4)
  v_mfma_f32_32x32x16_bf16 v[16:31], v[112:115], v[80:83], v[16:31]
  v_mfma_f32_32x32x16_bf16 v[32:47], v[112:115], v[84:87], v[32:47]
  s_add_u32 m0, s31, 4096
  s_add_u32 s36, s32, 0
  buffer_load_dwordx4 v12, s[52:55], s36 offen lds
  s_add_u32 m0, s31, 5120
  s_add_u32 s36, s32, 8192
  buffer_load_dwordx4 v12, s[52:55], s36 offen lds
  s_add_u32 s32, s32, 16384
  v_mfma_f32_32x32x16_bf16 v[48:63], v[116:119], v[80:83], v[48:63]
  v_mfma_f32_32x32x16_bf16 v[64:79], v[116:119], v[84:87], v[64:79]
  buffer_load_dwordx4 v[80:83], v13, s[8:11], s33 offen sc1
  buffer_load_dwordx4 v[84:87], v13, s[8:11], s34 offen sc1
  s_add_u32 s33, s33, 1024
  s_add_u32 s34, s34, 1024
  s_waitcnt vmcnt(6)
  ds_read_b64_tr_b16 v[112:113], v14 offset:2048
  ds_read_b64_tr_b16 v[114:115], v14 offset:3072
  ds_read_b64_tr_b16 v[116:117], v15 offset:2048
  ds_read_b64_tr_b16 v[118:119], v15 offset:3072
  s_waitcnt lgkmcnt(4)
  v_mfma_f32_32x32x16_bf16 v[16:31], v[120:123], v[88:91], v[16:31]
  v_mfma_f32_32x32x16_bf16 v[32:47], v[120:123], v[92:95], v[32:47]
  s_add_u32 m0, s31, 0
  s_add_u32 s36, s32, 0
  buffer_load_dwordx4 v12, s[52:55], s36 offen lds
  s_add_u32 m0, s31, 1024
  s_add_u32 s36, s32, 8192
  buffer_load_dwordx4 v12, s[52:55], s36 offen lds
  s_add_u32 s32, s32, 16384
  v_mfma_f32_32x32x16_bf16 v[48:63], v[124:127], v[88:91], v[48:63]
  v_mfma_f32_32x32x16_bf16 v[64:79], v[124:127], v[92:95], v[64:79]
  buffer_load_dwordx4 v[88:91], v13, s[8:11], s33 offen sc1
  buffer_load_dwordx4 v[92:95], v13, s[8:11], s34 offen sc1
  s_add_u32 s33, s33, 1024
  s_add_u32 s34, s34, 1024
  s_waitcnt vmcnt(6)
  ds_read_b64_tr_b16 v[120:121], v14 offset:4096
  ds_read_b64_tr_b16 v[122:123], v14 offset:5120
  ds_read_b64_tr_b16 v[124:125], v15 offset:4096
  ds_read_b64_tr_b16 v[126:127], v15 offset:5120
  s_waitcnt lgkmcnt(4)
  v_mfma_f32_32x32x16_bf16 v[16:31], v[112:115], v[96:99], v[16:31]
  v_mfma_f32_32x32x16_bf16 v[32:47], v[112:115], v[100:103], v[32:47]
  s_add_u32 m0, s31, 2048
  s_add_u32 s36, s32, 0
  buffer_load_dwordx4 v12, s[52:55], s36 offen lds
  s_add_u32 m0, s31, 3072
  s_add_u32 s36, s32, 8192
  buffer_load_dwordx4 v12, s[52:55], s36 offen lds
  s_add_u32 s32, s32, 16384
  v_mfma_f32_32x32x16_bf16 v[48:63], v[116:119], v[96:99], v[48:63]
  v_mfma_f32_32x32x16_bf16 v[64:79], v[116:119], v[100:103], v[64:79]
  buffer_load_dwordx4 v[96:99], v13, s[8:11], s33 offen sc1
  buffer_load_dwordx4 v[100:103], v13, s[8:11], s34 offen sc1
  s_add_u32 s33, s33, 1024
  s_add_u32 s34, s34, 1024
  s_waitcnt vmcnt(6)
  ds_read_b64_tr_b16 v[112:113], v14 offset:0
  ds_read_b64_tr_b16 v[114:115], v14 offset:1024
  ds_read_b64_tr_b16 v[116:117], v15 offset:0
  ds_read_b64_tr_b16 v[118:119], v15 offset:1024
  s_waitcnt lgkmcnt(4)
  v_mfma_f32_32x32x16_bf16 v[16:31], v[120:123], v[104:107], v[16:31]
  v_mfma_f32_32x32x16_bf16 v[32:47], v[120:123], v[108:111], v[32:47]
  s_add_u32 m0, s31, 4096
  s_add_u32 s36, s32, 0
  buffer_load_dwordx4 v12, s[52:55], s36 offen lds
  s_add_u32 m0, s31, 5120
  s_add_u32 s36, s32, 8192
  buffer_load_dwordx4 v12, s[52:55], s36 offen lds
  s_add_u32 s32, s32, 16384
  v_mfma_f32_32x32x16_bf16 v[48:63], v[124:127], v[104:107], v[48:63]
  v_mfma_f32_32x32x16_bf16 v[64:79], v[124:127], v[108:111], v[64:79]
  buffer_load_dwordx4 v[104:107], v13, s[8:11], s33 offen sc1
  buffer_load_dwordx4 v[108:111], v13, s[8:11], s34 offen sc1
  s_add_u32 s33, s33, 1024
  s_add_u32 s34, s34, 1024
  s_waitcnt vmcnt(6)
  ds_read_b64_tr_b16 v[120:121], v14 offset:2048
  ds_read_b64_tr_b16 v[122:123], v14 offset:3072
  ds_read_b64_tr_b16 v[124:125], v15 offset:2048
  ds_read_b64_tr_b16 v[126:127], v15 offset:3072
  s_waitcnt lgkmcnt(4)
  v_mfma_f32_32x32x16_bf16 v[16:31], v[112:115], v[80:83], v[16:31]
  v_mfma_f32_32x32x16_bf16 v[32:47], v[112:115], v[84:87], v[32:47]
  s_add_u32 m0, s31, 0
  s_add_u32 s36, s32, 0
  buffer_load_dwordx4 v12, s[52:55], s36 offen lds
  s_add_u32 m0, s31, 1024
  s_add_u32 s36, s32, 8192
  buffer_load_dwordx4 v12, s[52:55], s36 offen lds
  s_add_u32 s32, s32, 16384
  v_mfma_f32_32x32x16_bf16 v[48:63], v[116:119], v[80:83], v[48:63]
  v_mfma_f32_32x32x16_bf16 v[64:79], v[116:119], v[84:87], v[64:79]
  buffer_load_dwordx4 v[80:83], v13, s[8:11], s33 offen sc1
  buffer_load_dwordx4 v[84:87], v13, s[8:11], s34 offen sc1
  s_add_u32 s33, s33, 1024
  s_add_u32 s34, s34, 1024
  s_waitcnt vmcnt(6)
  ds_read_b64_tr_b16 v[112:113], v14 offset:4096
  ds_read_b64_tr_b16 v[114:115], v14 offset:5120
  ds_read_b64_tr_b16 v[116:117], v15 offset:4096
  ds_read_b64_tr_b16 v[118:119], v15 offset:5120
  s_waitcnt lgkmcnt(4)
  v_mfma_f32_32x32x16_bf16 v[16:31], v[120:123], v[88:91], v[16:31]
  v_mfma_f32_32x32x16_bf16 v[32:47], v[120:123], v[92:95], v[32:47]
  s_add_u32 m0, s31, 2048
  s_add_u32 s36, s32, 0
  buffer_load_dwordx4 v12, s[52:55], s36 offen lds
  s_add_u32 m0, s31, 3072
  s_add_u32 s36, s32, 8192
  buffer_load_dwordx4 v12, s[52:55], s36 offen lds
  s_add_u32 s32, s32, 16384
  v_mfma_f32_32x32x16_bf16 v[48:63], v[124:127], v[88:91], v[48:63]
  v_mfma_f32_32x32x16_bf16 v[64:79], v[124:127], v[92:95], v[64:79]
  buffer_load_dwordx4 v[88:91], v13, s[8:11], s33 offen sc1
  buffer_load_dwordx4 v[92:95], v13, s[8:11], s34 offen sc1
  s_add_u32 s33, s33, 1024
  s_add_u32 s34, s34, 1024
  s_waitcnt vmcnt(6)
  ds_read_b64_tr_b16 v[120:121], v14 offset:0
  ds_read_b64_tr_b16 v[122:123], v14 offset:1024
  ds_read_b64_tr_b16 v[124:125], v15 offset:0
  ds_read_b64_tr_b16 v[126:127], v15 offset:1024
  s_waitcnt lgkmcnt(4)
  v_mfma_f32_32x32x16_bf16 v[16:31], v[112:115], v[96:99], v[16:31]
  v_mfma_f32_32x32x16_bf16 v[32:47], v[112:115], v[100:103], v[32:47]
  s_add_u32 m0, s31, 4096
  s_add_u32 s36, s32, 0
  buffer_load_dwordx4 v12, s[52:55], s36 offen lds
  s_add_u32 m0, s31, 5120
  s_add_u32 s36, s32, 8192
  buffer_load_dwordx4 v12, s[52:55], s36 offen lds
  s_add_u32 s32, s32, 16384
  v_mfma_f32_32x32x16_bf16 v[48:63], v[116:119], v[96:99], v[48:63]
  v_mfma_f32_32x32x16_bf16 v[64:79], v[116:119], v[100:103], v[64:79]
  buffer_load_dwordx4 v[96:99], v13, s[8:11], s33 offen sc1
  buffer_load_dwordx4 v[100:103], v13, s[8:11], s34 offen sc1
  s_add_u32 s33, s33, 1024
  s_add_u32 s34, s34, 1024
  s_waitcnt vmcnt(6)
  ds_read_b64_tr_b16 v[112:113], v14 offset:2048
  ds_read_b64_tr_b16 v[114:115], v14 offset:3072
  ds_read_b64_tr_b16 v[116:117], v15 offset:2048
  ds_read_b64_tr_b16 v[118:119], v15 offset:3072
  s_waitcnt lgkmcnt(4)
  v_mfma_f32_32x32x16_bf16 v[16:31], v[120:123], v[104:107], v[16:31]
  v_mfma_f32_32x32x16_bf16 v[32:47], v[120:123], v[108:111], v[32:47]
  s_add_u32 m0, s31, 0
  s_add_u32 s36, s32, 0
  buffer_load_dwordx4 v12, s[52:55], s36 offen lds
  s_add_u32 m0, s31, 1024
  s_add_u32 s36, s32, 8192
  buffer_load_dwordx4 v12, s[52:55], s36 offen lds
  s_add_u32 s32, s32, 16384
  v_mfma_f32_32x32x16_bf16 v[48:63], v[124:127], v[104:107], v[48:63]
  v_mfma_f32_32x32x16_bf16 v[64:79], v[124:127], v[108:111], v[64:79]
  buffer_load_dwordx4 v[104:107], v13, s[8:11], s33 offen sc1
  buffer_load_dwordx4 v[108:111], v13, s[8:11], s34 offen sc1
  s_add_u32 s33, s33, 1024
  s_add_u32 s34, s34, 1024
  s_waitcnt vmcnt(6)
  ds_read_b64_tr_b16 v[120:121], v14 offset:4096
  ds_read_b64_tr_b16 v[122:123], v14 offset:5120
  ds_read_b64_tr_b16 v[124:125], v15 offset:4096
  ds_read_b64_tr_b16 v[126:127], v15 offset:5120
  s_waitcnt lgkmcnt(4)
  v_mfma_f32_32x32x16_bf16 v[16:31], v[112:115], v[80:83], v[16:31]
  v_mfma_f32_32x32x16_bf16 v[32:47], v[112:115], v[84:87], v[32:47]
  s_add_u32 m0, s31, 2048
  s_add_u32 s36, s32, 0
  buffer_load_dwordx4 v12, s[52:55], s36 offen lds
  s_add_u32 m0, s31, 3072
  s_add_u32 s36, s32, 8192
  buffer_load_dwordx4 v12, s[52:55], s36 offen lds
  s_add_u32 s32, s32, 16384
  v_mfma_f32_32x32x16_bf16 v[48:63], v[116:119], v[80:83], v[48:63]
  v_mfma_f32_32x32x16_bf16 v[64:79], v[116:119], v[84:87], v[64:79]
  buffer_load_dwordx4 v[80:83], v13, s[8:11], s33 offen sc1
  buffer_load_dwordx4 v[84:87], v13, s[8:11], s34 offen sc1
  s_add_u32 s33, s33, 1024
  s_add_u32 s34, s34, 1024
  s_waitcnt vmcnt(6)
  ds_read_b64_tr_b16 v[112:113], v14 offset:0
  ds_read_b64_tr_b16 v[114:115], v14 offset:1024
  ds_read_b64_tr_b16 v[116:117], v15 offset:0
  ds_read_b64_tr_b16 v[118:119], v15 offset:1024
  s_waitcnt lgkmcnt(4)
  v_mfma_f32_32x32x16_bf16 v[16:31], v[120:123], v[88:91], v[16:31]
  v_mfma_f32_32x32x16_bf16 v[32:47], v[120:123], v[92:95], v[32:47]
  s_add_u32 m0, s31, 4096
  s_add_u32 s36, s32, 0
  buffer_load_dwordx4 v12, s[52:55], s36 offen lds
  s_add_u32 m0, s31, 5120
  s_add_u32 s36, s32, 8192
  buffer_load_dwordx4 v12, s[52:55], s36 offen lds
  s_add_u32 s32, s32, 16384
  v_mfma_f32_32x32x16_bf16 v[48:63], v[124:127], v[88:91], v[48:63]
  v_mfma_f32_32x32x16_bf16 v[64:79], v[124:127], v[92:95], v[64:79]
  buffer_load_dwordx4 v[88:91], v13, s[8:11], s33 offen sc1
  buffer_load_dwordx4 v[92:95], v13, s[8:11], s34 offen sc1
  s_add_u32 s33, s33, 1024
  s_add_u32 s34, s34, 1024
  s_waitcnt vmcnt(6)
  ds_read_b64_tr_b16 v[120:121], v14 offset:2048
  ds_read_b64_tr_b16 v[122:123], v14 offset:3072
  ds_read_b64_tr_b16 v[124:125], v15 offset:2048
  ds_read_b64_tr_b16 v[126:127], v15 offset:3072
  s_waitcnt lgkmcnt(4)
  v_mfma_f32_32x32x16_bf16 v[16:31], v[112:115], v[96:99], v[16:31]
  v_mfma_f32_32x32x16_bf16 v[32:47], v[112:115], v[100:103], v[32:47]
  s_add_u32 m0, s31, 0
  s_add_u32 s36, s32, 0
  buffer_load_dwordx4 v12, s[52:55], s36 offen lds
  s_add_u32 m0, s31, 1024
  s_add_u32 s36, s32, 8192
  buffer_load_dwordx4 v12, s[52:55], s36 offen lds
  s_add_u32 s32, s32, 16384
  v_mfma_f32_32x32x16_bf16 v[48:63], v[116:119], v[96:99], v[48:63]
  v_mfma_f32_32x32x16_bf16 v[64:79], v[116:119], v[100:103], v[64:79]
  buffer_load_dwordx4 v[96:99], v13, s[8:11], s33 offen sc1
  buffer_load_dwordx4 v[100:103], v13, s[8:11], s34 offen sc1
  s_add_u32 s33, s33, 1024
  s_add_u32 s34, s34, 1024
  s_waitcnt vmcnt(6)
  ds_read_b64_tr_b16 v[112:113], v14 offset:4096
  ds_read_b64_tr_b16 v[114:115], v14 offset:5120
  ds_read_b64_tr_b16 v[116:117], v15 offset:4096
  ds_read_b64_tr_b16 v[118:119], v15 offset:5120
  s_waitcnt lgkmcnt(4)
  v_mfma_f32_32x32x16_bf16 v[16:31], v[120:123], v[104:107], v[16:31]
  v_mfma_f32_32x32x16_bf16 v[32:47], v[120:123], v[108:111], v[32:47]
  s_add_u32 m0, s31, 2048
  s_add_u32 s36, s32, 0
  buffer_load_dwordx4 v12, s[52:55], s36 offen lds
  s_add_u32 m0, s31, 3072
  s_add_u32 s36, s32, 8192
  buffer_load_dwordx4 v12, s[52:55], s36 offen lds
  s_add_u32 s32, s32, 16384
  v_mfma_f32_32x32x16_bf16 v[48:63], v[124:127], v[104:107], v[48:63]
  v_mfma_f32_32x32x16_bf16 v[64:79], v[124:127], v[108:111], v[64:79]
  buffer_load_dwordx4 v[104:107], v13, s[8:11], s33 offen sc1
  buffer_load_dwordx4 v[108:111], v13, s[8:11], s34 offen sc1
  s_add_u32 s33, s33, 1024
  s_add_u32 s34, s34, 1024
  s_waitcnt vmcnt(6)
  ds_read_b64_tr_b16 v[120:121], v14 offset:0
  ds_read_b64_tr_b16 v[122:123], v14 offset:1024
  ds_read_b64_tr_b16 v[124:125], v15 offset:0
  ds_read_b64_tr_b16 v[126:127], v15 offset:1024
  s_waitcnt lgkmcnt(4)
  v_mfma_f32_32x32x16_bf16 v[16:31], v[112:115], v[80:83], v[16:31]
  v_mfma_f32_32x32x16_bf16 v[32:47], v[112:115], v[84:87], v[32:47]
  s_add_u32 m0, s31, 4096
  s_add_u32 s36, s32, 0
  buffer_load_dwordx4 v12, s[52:55], s36 offen lds
  s_add_u32 m0, s31, 5120
  s_add_u32 s36, s32, 8192
  buffer_load_dwordx4 v12, s[52:55], s36 offen lds
  s_add_u32 s32, s32, 16384
  v_mfma_f32_32x32x16_bf16 v[48:63], v[116:119], v[80:83], v[48:63]
  v_mfma_f32_32x32x16_bf16 v[64:79], v[116:119], v[84:87], v[64:79]
  buffer_load_dwordx4 v[80:83], v13, s[8:11], s33 offen sc1
  buffer_load_dwordx4 v[84:87], v13, s[8:11], s34 offen sc1
  s_add_u32 s33, s33, 1024
  s_add_u32 s34, s34, 1024
  s_waitcnt vmcnt(6)
  ds_read_b64_tr_b16 v[112:113], v14 offset:2048
  ds_read_b64_tr_b16 v[114:115], v14 offset:3072
  ds_read_b64_tr_b16 v[116:117], v15 offset:2048
  ds_read_b64_tr_b16 v[118:119], v15 offset:3072
  s_waitcnt lgkmcnt(4)
  v_mfma_f32_32x32x16_bf16 v[16:31], v[120:123], v[88:91], v[16:31]
  v_mfma_f32_32x32x16_bf16 v[32:47], v[120:123], v[92:95], v[32:47]
  s_add_u32 m0, s31, 0
  s_add_u32 s36, s32, 0
  buffer_load_dwordx4 v12, s[52:55], s36 offen lds
  s_add_u32 m0, s31, 1024
  s_add_u32 s36, s32, 8192
  buffer_load_dwordx4 v12, s[52:55], s36 offen lds
  s_add_u32 s32, s32, 16384
  v_mfma_f32_32x32x16_bf16 v[48:63], v[124:127], v[88:91], v[48:63]
  v_mfma_f32_32x32x16_bf16 v[64:79], v[124:127], v[92:95], v[64:79]
  buffer_load_dwordx4 v[88:91], v13, s[8:11], s33 offen sc1
  buffer_load_dwordx4 v[92:95], v13, s[8:11], s34 offen sc1
  s_add_u32 s33, s33, 1024
  s_add_u32 s34, s34, 1024
  s_waitcnt vmcnt(6)
  ds_read_b64_tr_b16 v[120:121], v14 offset:4096
  ds_read_b64_tr_b16 v[122:123], v14 offset:5120
  ds_read_b64_tr_b16 v[124:125], v15 offset:4096
  ds_read_b64_tr_b16 v[126:127], v15 offset:5120
  s_waitcnt lgkmcnt(4)
  v_mfma_f32_32x32x16_bf16 v[16:31], v[112:115], v[96:99], v[16:31]
  v_mfma_f32_32x32x16_bf16 v[32:47], v[112:115], v[100:103], v[32:47]
  s_add_u32 m0, s31, 2048
  s_add_u32 s36, s32, 0
  buffer_load_dwordx4 v12, s[52:55], s36 offen lds
  s_add_u32 m0, s31, 3072
  s_add_u32 s36, s32, 8192
  buffer_load_dwordx4 v12, s[52:55], s36 offen lds
  s_add_u32 s32, s32, 16384
  v_mfma_f32_32x32x16_bf16 v[48:63], v[116:119], v[96:99], v[48:63]
  v_mfma_f32_32x32x16_bf16 v[64:79], v[116:119], v[100:103], v[64:79]
  buffer_load_dwordx4 v[96:99], v13, s[8:11], s33 offen sc1
  buffer_load_dwordx4 v[100:103], v13, s[8:11], s34 offen sc1
  s_add_u32 s33, s33, 1024
  s_add_u32 s34, s34, 1024
  s_waitcnt vmcnt(6)
  ds_read_b64_tr_b16 v[112:113], v14 offset:0
  ds_read_b64_tr_b16 v[114:115], v14 offset:1024
  ds_read_b64_tr_b16 v[116:117], v15 offset:0
  ds_read_b64_tr_b16 v[118:119], v15 offset:1024
  s_waitcnt lgkmcnt(4)
  v_mfma_f32_32x32x16_bf16 v[16:31], v[120:123], v[104:107], v[16:31]
  v_mfma_f32_32x32x16_bf16 v[32:47], v[120:123], v[108:111], v[32:47]
  s_add_u32 m0, s31, 4096
  s_add_u32 s36, s32, 0
  buffer_load_dwordx4 v12, s[52:55], s36 offen lds
  s_add_u32 m0, s31, 5120
  s_add_u32 s36, s32, 8192
  buffer_load_dwordx4 v12, s[52:55], s36 offen lds
  s_add_u32 s32, s32, 16384
  v_mfma_f32_32x32x16_bf16 v[48:63], v[124:127], v[104:107], v[48:63]
  v_mfma_f32_32x32x16_bf16 v[64:79], v[124:127], v[108:111], v[64:79]
  buffer_load_dwordx4 v[104:107], v13, s[8:11], s33 offen sc1
  buffer_load_dwordx4 v[108:111], v13, s[8:11], s34 offen sc1
  s_add_u32 s33, s33, 1024
  s_add_u32 s34, s34, 1024
  s_waitcnt vmcnt(6)
  ds_read_b64_tr_b16 v[120:121], v14 offset:2048
  ds_read_b64_tr_b16 v[122:123], v14 offset:3072
  ds_read_b64_tr_b16 v[124:125], v15 offset:2048
  ds_read_b64_tr_b16 v[126:127], v15 offset:3072
  s_waitcnt lgkmcnt(4)
  v_mfma_f32_32x32x16_bf16 v[16:31], v[112:115], v[80:83], v[16:31]
  v_mfma_f32_32x32x16_bf16 v[32:47], v[112:115], v[84:87], v[32:47]
  s_add_u32 m0, s31, 0
  s_add_u32 s36, s32, 0
  buffer_load_dwordx4 v12, s[52:55], s36 offen lds
  s_add_u32 m0, s31, 1024
  s_add_u32 s36, s32, 8192
  buffer_load_dwordx4 v12, s[52:55], s36 offen lds
  s_add_u32 s32, s32, 16384
  v_mov_b32 v2, 159760
  s_mov_b32 s42, 0
L_lw_1:
  ds_read_b32 v3, v2
  s_waitcnt lgkmcnt(0)
  v_readfirstlane_b32 s43, v3
  s_add_u32 s42, s42, 1
  s_cmp_ge_u32 s43, 8
  s_cbranch_scc1 L_lwd_2
  s_cmp_lt_u32 s42, 0x40000
  s_cbranch_scc1 L_lw_1
L_lwd_2:
  s_mov_b32 s56, s80
  s_mov_b32 s57, s81
  s_mov_b32 s58, 524288
  s_mov_b32 s59, 0x20000
  s_lshl_b32 s86, s30, 17
  s_lshl_b32 s47, s13, 7
  s_add_u32 s86, s86, s47
  s_mul_i32 s87, s48, 66560
  s_add_u32 s87, s87, 16384
  s_lshl_b32 s47, s49, 14
  s_add_u32 s87, s87, s47
  s_add_u32 m0, s87, 0
  s_add_u32 s36, s86, 0
  buffer_load_dwordx4 v12, s[56:59], s36 offen lds
  s_add_u32 m0, s87, 1024
  s_add_u32 s36, s86, 8192
  buffer_load_dwordx4 v12, s[56:59], s36 offen lds
  s_add_u32 m0, s87, 2048
  s_add_u32 s36, s86, 16384
  buffer_load_dwordx4 v12, s[56:59], s36 offen lds
  s_add_u32 m0, s87, 3072
  s_add_u32 s36, s86, 24576
  buffer_load_dwordx4 v12, s[56:59], s36 offen lds
  v_mfma_f32_32x32x16_bf16 v[48:63], v[116:119], v[80:83], v[48:63]
  v_mfma_f32_32x32x16_bf16 v[64:79], v[116:119], v[84:87], v[64:79]
  s_waitcnt vmcnt(8)
  ds_read_b64_tr_b16 v[112:113], v14 offset:4096
  ds_read_b64_tr_b16 v[114:115], v14 offset:5120
  ds_read_b64_tr_b16 v[116:117], v15 offset:4096
  ds_read_b64_tr_b16 v[118:119], v15 offset:5120
  s_waitcnt lgkmcnt(4)
  v_mfma_f32_32x32x16_bf16 v[16:31], v[120:123], v[88:91], v[16:31]
  v_mfma_f32_32x32x16_bf16 v[32:47], v[120:123], v[92:95], v[32:47]
  s_add_u32 m0, s87, 4096
  s_add_u32 s36, s86, 32768
  buffer_load_dwordx4 v12, s[56:59], s36 offen lds
  s_add_u32 m0, s87, 5120
  s_add_u32 s36, s86, 40960
  buffer_load_dwordx4 v12, s[56:59], s36 offen lds
  s_add_u32 m0, s87, 6144
  s_add_u32 s36, s86, 49152
  buffer_load_dwordx4 v12, s[56:59], s36 offen lds
  s_add_u32 m0, s87, 7168
  s_add_u32 s36, s86, 57344
  buffer_load_dwordx4 v12, s[56:59], s36 offen lds
  v_mfma_f32_32x32x16_bf16 v[48:63], v[124:127], v[88:91], v[48:63]
  v_mfma_f32_32x32x16_bf16 v[64:79], v[124:127], v[92:95], v[64:79]
  s_waitcnt vmcnt(8)
  ds_read_b64_tr_b16 v[120:121], v14 offset:0
  ds_read_b64_tr_b16 v[122:123], v14 offset:1024
  ds_read_b64_tr_b16 v[124:125], v15 offset:0
  ds_read_b64_tr_b16 v[126:127], v15 offset:1024
  s_waitcnt lgkmcnt(4)
  v_mfma_f32_32x32x16_bf16 v[16:31], v[112:115], v[96:99], v[16:31]
  v_mfma_f32_32x32x16_bf16 v[32:47], v[112:115], v[100:103], v[32:47]
  s_add_u32 m0, s87, 8192
  s_add_u32 s36, s86, 65536
  buffer_load_dwordx4 v12, s[56:59], s36 offen lds
  s_add_u32 m0, s87, 9216
  s_add_u32 s36, s86, 73728
  buffer_load_dwordx4 v12, s[56:59], s36 offen lds
  s_add_u32 m0, s87, 10240
  s_add_u32 s36, s86, 81920
  buffer_load_dwordx4 v12, s[56:59], s36 offen lds
  s_add_u32 m0, s87, 11264
  s_add_u32 s36, s86, 90112
  buffer_load_dwordx4 v12, s[56:59], s36 offen lds
  v_mfma_f32_32x32x16_bf16 v[48:63], v[116:119], v[96:99], v[48:63]
  v_mfma_f32_32x32x16_bf16 v[64:79], v[116:119], v[100:103], v[64:79]
  s_waitcnt lgkmcnt(0)
  v_mfma_f32_32x32x16_bf16 v[16:31], v[120:123], v[104:107], v[16:31]
  v_mfma_f32_32x32x16_bf16 v[32:47], v[120:123], v[108:111], v[32:47]
  s_add_u32 m0, s87, 12288
  s_add_u32 s36, s86, 98304
  buffer_load_dwordx4 v12, s[56:59], s36 offen lds
  s_add_u32 m0, s87, 13312
  s_add_u32 s36, s86, 106496
  buffer_load_dwordx4 v12, s[56:59], s36 offen lds
  s_add_u32 m0, s87, 14336
  s_add_u32 s36, s86, 114688
  buffer_load_dwordx4 v12, s[56:59], s36 offen lds
  s_add_u32 m0, s87, 15360
  s_add_u32 s36, s86, 122880
  buffer_load_dwordx4 v12, s[56:59], s36 offen lds
  v_mfma_f32_32x32x16_bf16 v[48:63], v[124:127], v[104:107], v[48:63]
  v_mfma_f32_32x32x16_bf16 v[64:79], v[124:127], v[108:111], v[64:79]
  s_setprio 3
  s_nop 11
  s_mul_i32 s46, s30, 6144
  s_add_u32 s46, s46, 135168
  v_add_u32 v5, s46, v13
  ds_write_b128 v5, v[32:35] offset:0
  ds_write_b128 v5, v[36:39] offset:1024
  ds_write_b128 v5, v[40:43] offset:2048
  ds_write_b128 v5, v[44:47] offset:3072
  s_lshl_b32 s46, s30, 12
  v_add_u32 v6, s46, v13
  ds_write_b128 v6, v[48:51] offset:0
  ds_write_b128 v6, v[52:55] offset:1024
  ds_write_b128 v6, v[56:59] offset:2048
  ds_write_b128 v6, v[60:63] offset:3072
  s_lshl_b32 s46, s30, 12
  s_add_u32 s46, s46, 65536
  v_add_u32 v7, s46, v13
  ds_write_b128 v7, v[64:67] offset:0
  ds_write_b128 v7, v[68:71] offset:1024
  ds_write_b128 v7, v[72:75] offset:2048
  ds_write_b128 v7, v[76:79] offset:3072
  s_mov_b32 s56, s82
  s_mov_b32 s57, s83
  s_mov_b32 s58, 2097152
  s_mov_b32 s59, 0x20000
  v_lshrrev_b32 v4, 2, v1
  v_and_b32 v5, 3, v1
  v_lshlrev_b32 v5, 4, v5
  v_lshl_add_u32 v0, v4, 10, v5
  s_lshl_b32 s44, s12, 1
  s_add_u32 s44, s44, s49
  s_lshl_b32 s44, s44, 15
  s_lshl_b32 s45, s13, 1
  s_add_u32 s45, s45, s48
  s_lshl_b32 s45, s45, 6
  s_add_u32 s44, s44, s45
  s_add_u32 s45, s44, 16384
  buffer_load_dwordx4 v[64:67], v0, s[56:59], s44 offen
  buffer_load_dwordx4 v[68:71], v0, s[56:59], s45 offen
  v_and_b32 v11, 15, v1
  v_lshlrev_b32 v11, 2, v11
  s_lshl_b32 s50, s2, 11
  s_lshl_b32 s47, s49, 7
  s_add_u32 s50, s50, s47
  s_lshl_b32 s47, s48, 6
  s_add_u32 s50, s50, s47
  s_add_u32 s50, s50, 20972672
  buffer_load_dword v12, v11, s[8:11], s50 offen sc1
  v_lshrrev_b32 v4, 5, v1
  v_lshlrev_b32 v4, 3, v4
  v_bfe_u32 v5, v1, 2, 2
  v_add_u32 v4, v4, v5
  v_lshlrev_b32 v4, 7, v4
  v_lshrrev_b32 v5, 1, v5
  v_xor_b32 v5, s48, v5
  v_lshl_add_u32 v4, v5, 6, v4
  v_bfe_u32 v5, v1, 4, 1
  v_lshl_add_u32 v4, v5, 5, v4
  v_and_b32 v5, 3, v1
  v_lshl_add_u32 v4, v5, 3, v4
  s_mul_i32 s46, s48, 66560
  s_add_u32 s46, s46, 16384
  v_add_u32 v14, s46, v4
  v_xor_b32 v15, 64, v14
  s_and_b32 s46, s30, 1
  s_mul_i32 s46, s46, 4608
  s_cmp_eq_u32 s48, 0
  s_cselect_b32 s47, 0, 65536
  s_add_u32 s46, s46, s47
  v_and_b32 v4, 31, v1
  v_mul_u32_u24 v4, 144, v4
  v_lshrrev_b32 v5, 5, v1
  v_lshl_add_u32 v4, v5, 4, v4
  v_add_u32 v8, s46, v4
  v_lshrrev_b32 v4, 2, v1
  v_mul_u32_u24 v4, 144, v4
  v_and_b32 v5, 3, v1
  v_lshl_add_u32 v4, v5, 5, v4
  v_add_u32 v10, s46, v4
  s_waitcnt lgkmcnt(0)
  s_add_u32 s38, s38, 4
  v_mov_b32 v2, 159744
  v_mov_b32 v3, 1
  s_mov_b64 s[40:41], exec
  s_mov_b64 exec, 1
  ds_add_u32 v2, v3
  s_mov_b64 exec, s[40:41]
  s_mov_b32 s42, 0
L_k2_kernel_mb_3:
  ds_read_b32 v3, v2
  s_waitcnt lgkmcnt(0)
  v_readfirstlane_b32 s43, v3
  s_add_u32 s42, s42, 1
  s_cmp_ge_u32 s43, s38
  s_cbranch_scc1 L_k2_kernel_mbd_4
  s_cmp_ge_u32 s42, 0x20000
  s_cbranch_scc1 L_k2_kernel_mbd_4
  s_branch L_k2_kernel_mb_3
L_k2_kernel_mbd_4:
  s_xor_b32 s47, s30, 1
  s_mul_i32 s46, s47, 6144
  s_add_u32 s46, s46, 135168
  v_add_u32 v5, s46, v13
  ds_read_b128 v[80:83], v5 offset:0
  ds_read_b128 v[84:87], v5 offset:1024
  ds_read_b128 v[88:91], v5 offset:2048
  ds_read_b128 v[92:95], v5 offset:3072
  s_xor_b32 s47, s30, 2
  s_lshl_b32 s46, s47, 12
  v_add_u32 v6, s46, v13
  ds_read_b128 v[96:99], v6 offset:0
  ds_read_b128 v[100:103], v6 offset:1024
  ds_read_b128 v[104:107], v6 offset:2048
  ds_read_b128 v[108:111], v6 offset:3072
  s_xor_b32 s47, s30, 3
  s_lshl_b32 s46, s47, 12
  s_add_u32 s46, s46, 65536
  v_add_u32 v7, s46, v13
  ds_read_b128 v[112:115], v7 offset:0
  ds_read_b128 v[116:119], v7 offset:1024
  ds_read_b128 v[120:123], v7 offset:2048
  ds_read_b128 v[124:127], v7 offset:3072
  s_waitcnt lgkmcnt(8)
  v_add_f32 v16, v16, v80
  v_add_f32 v17, v17, v81
  v_add_f32 v18, v18, v82
  v_add_f32 v19, v19, v83
  v_add_f32 v20, v20, v84
  v_add_f32 v21, v21, v85
  v_add_f32 v22, v22, v86
  v_add_f32 v23, v23, v87
  v_add_f32 v24, v24, v88
  v_add_f32 v25, v25, v89
  v_add_f32 v26, v26, v90
  v_add_f32 v27, v27, v91
  v_add_f32 v28, v28, v92
  v_add_f32 v29, v29, v93
  v_add_f32 v30, v30, v94
  v_add_f32 v31, v31, v95
  s_waitcnt lgkmcnt(4)
  v_add_f32 v16, v16, v96
  v_add_f32 v17, v17, v97
  v_add_f32 v18, v18, v98
  v_add_f32 v19, v19, v99
  v_add_f32 v20, v20, v100
  v_add_f32 v21, v21, v101
  v_add_f32 v22, v22, v102
  v_add_f32 v23, v23, v103
  v_add_f32 v24, v24, v104
  v_add_f32 v25, v25, v105
  v_add_f32 v26, v26, v106
  v_add_f32 v27, v27, v107
  v_add_f32 v28, v28, v108
  v_add_f32 v29, v29, v109
  v_add_f32 v30, v30, v110
  v_add_f32 v31, v31, v111
  s_waitcnt lgkmcnt(0)
  v_add_f32 v16, v16, v112
  v_add_f32 v17, v17, v113
  v_add_f32 v18, v18, v114
  v_add_f32 v19, v19, v115
  v_add_f32 v20, v20, v116
  v_add_f32 v21, v21, v117
  v_add_f32 v22, v22, v118
  v_add_f32 v23, v23, v119
  v_add_f32 v24, v24, v120
  v_add_f32 v25, v25, v121
  v_add_f32 v26, v26, v122
  v_add_f32 v27, v27, v123
  v_add_f32 v28, v28, v124
  v_add_f32 v29, v29, v125
  v_add_f32 v30, v30, v126
  v_add_f32 v31, v31, v127
  s_waitcnt vmcnt(0)
  v_cmp_eq_u32 vcc, 1, v12
  s_mov_b32 s51, 0
  s_nop 0
  s_cmp_eq_u64 vcc, -1
  s_cbranch_scc0 L_onr_5
  s_mov_b32 s51, 1
  s_lshl_b32 s39, s12, 1
  s_add_u32 s39, s39, s49
  s_lshl_b32 s39, s39, 5
  s_lshl_b32 s47, s48, 4
  s_add_u32 s39, s39, s47
  s_lshl_b32 s39, s39, 10
  s_add_u32 s39, s39, 18350080
  s_add_u32 s36, s39, 0
  buffer_load_dwordx4 v[80:83], v13, s[8:11], s36 offen sc1
  s_add_u32 s36, s39, 1024
  buffer_load_dwordx4 v[84:87], v13, s[8:11], s36 offen sc1
  s_add_u32 s36, s39, 2048
  buffer_load_dwordx4 v[88:91], v13, s[8:11], s36 offen sc1
  s_add_u32 s36, s39, 3072
  buffer_load_dwordx4 v[92:95], v13, s[8:11], s36 offen sc1
  s_add_u32 s36, s39, 4096
  buffer_load_dwordx4 v[96:99], v13, s[8:11], s36 offen sc1
  s_add_u32 s36, s39, 5120
  buffer_load_dwordx4 v[100:103], v13, s[8:11], s36 offen sc1
  s_add_u32 s36, s39, 6144
  buffer_load_dwordx4 v[104:107], v13, s[8:11], s36 offen sc1
  s_add_u32 s36, s39, 7168
  buffer_load_dwordx4 v[108:111], v13, s[8:11], s36 offen sc1
L_onr_5:
  v_mul_f32 v120, 0xbfb8aa3b, v16
  v_mul_f32 v121, 0xbfb8aa3b, v17
  v_mul_f32 v122, 0xbfb8aa3b, v18
  v_mul_f32 v123, 0xbfb8aa3b, v19
  v_exp_f32 v120, v120
  v_exp_f32 v121, v121
  v_exp_f32 v122, v122
  v_exp_f32 v123, v123
  s_nop 0
  v_add_f32 v120, 1.0, v120
  v_add_f32 v121, 1.0, v121
  v_add_f32 v122, 1.0, v122
  v_add_f32 v123, 1.0, v123
  v_rcp_f32 v120, v120
  v_rcp_f32 v121, v121
  v_rcp_f32 v122, v122
  v_rcp_f32 v123, v123
  s_nop 0
  v_mul_f32 v16, v16, v120
  v_mul_f32 v17, v17, v121
  v_mul_f32 v18, v18, v122
  v_mul_f32 v19, v19, v123
  v_mul_f32 v120, 0xbfb8aa3b, v20
  v_mul_f32 v121, 0xbfb8aa3b, v21
  v_mul_f32 v122, 0xbfb8aa3b, v22
  v_mul_f32 v123, 0xbfb8aa3b, v23
  v_exp_f32 v120, v120
  v_exp_f32 v121, v121
  v_exp_f32 v122, v122
  v_exp_f32 v123, v123
  s_nop 0
  v_add_f32 v120, 1.0, v120
  v_add_f32 v121, 1.0, v121
  v_add_f32 v122, 1.0, v122
  v_add_f32 v123, 1.0, v123
  v_rcp_f32 v120, v120
  v_rcp_f32 v121, v121
  v_rcp_f32 v122, v122
  v_rcp_f32 v123, v123
  s_nop 0
  v_mul_f32 v20, v20, v120
  v_mul_f32 v21, v21, v121
  v_mul_f32 v22, v22, v122
  v_mul_f32 v23, v23, v123
  v_mul_f32 v120, 0xbfb8aa3b, v24
  v_mul_f32 v121, 0xbfb8aa3b, v25
  v_mul_f32 v122, 0xbfb8aa3b, v26
  v_mul_f32 v123, 0xbfb8aa3b, v27
  v_exp_f32 v120, v120
  v_exp_f32 v121, v121
  v_exp_f32 v122, v122
  v_exp_f32 v123, v123
  s_nop 0
  v_add_f32 v120, 1.0, v120
  v_add_f32 v121, 1.0, v121
  v_add_f32 v122, 1.0, v122
  v_add_f32 v123, 1.0, v123
  v_rcp_f32 v120, v120
  v_rcp_f32 v121, v121
  v_rcp_f32 v122, v122
  v_rcp_f32 v123, v123
  s_nop 0
  v_mul_f32 v24, v24, v120
  v_mul_f32 v25, v25, v121
  v_mul_f32 v26, v26, v122
  v_mul_f32 v27, v27, v123
  v_mul_f32 v120, 0xbfb8aa3b, v28
  v_mul_f32 v121, 0xbfb8aa3b, v29
  v_mul_f32 v122, 0xbfb8aa3b, v30
  v_mul_f32 v123, 0xbfb8aa3b, v31
  v_exp_f32 v120, v120
  v_exp_f32 v121, v121
  v_exp_f32 v122, v122
  v_exp_f32 v123, v123
  s_nop 0
  v_add_f32 v120, 1.0, v120
  v_add_f32 v121, 1.0, v121
  v_add_f32 v122, 1.0, v122
  v_add_f32 v123, 1.0, v123
  v_rcp_f32 v120, v120
  v_rcp_f32 v121, v121
  v_rcp_f32 v122, v122
  v_rcp_f32 v123, v123
  s_nop 0
  v_mul_f32 v28, v28, v120
  v_mul_f32 v29, v29, v121
  v_mul_f32 v30, v30, v122
  v_mul_f32 v31, v31, v123
  s_waitcnt lgkmcnt(0)
  s_add_u32 s38, s38, 4
  v_mov_b32 v2, 159744
  v_mov_b32 v3, 1
  s_mov_b64 s[40:41], exec
  s_mov_b64 exec, 1
  ds_add_u32 v2, v3
  s_mov_b64 exec, s[40:41]
  s_mov_b32 s42, 0
L_k2_kernel_mb_6:
  ds_read_b32 v3, v2
  s_waitcnt lgkmcnt(0)
  v_readfirstlane_b32 s43, v3
  s_add_u32 s42, s42, 1
  s_cmp_ge_u32 s43, s38
  s_cbranch_scc1 L_k2_kernel_mbd_7
  s_cmp_ge_u32 s42, 0x20000
  s_cbranch_scc1 L_k2_kernel_mbd_7
  s_branch L_k2_kernel_mb_6
L_k2_kernel_mbd_7:
  v_lshlrev_b32 v32, 16, v64
  v_and_b32 v33, 0xffff0000, v64
  v_lshlrev_b32 v34, 16, v65
  v_and_b32 v35, 0xffff0000, v65
  v_lshlrev_b32 v36, 16, v66
  v_and_b32 v37, 0xffff0000, v66
  v_lshlrev_b32 v38, 16, v67
  v_and_b32 v39, 0xffff0000, v67
  v_lshlrev_b32 v40, 16, v68
  v_and_b32 v41, 0xffff0000, v68
  v_lshlrev_b32 v42, 16, v69
  v_and_b32 v43, 0xffff0000, v69
  v_lshlrev_b32 v44, 16, v70
  v_and_b32 v45, 0xffff0000, v70
  v_lshlrev_b32 v46, 16, v71
  v_and_b32 v47, 0xffff0000, v71
  ds_read_b64_tr_b16 v[112:113], v14 offset:0
  ds_read_b64_tr_b16 v[114:115], v14 offset:512
  ds_read_b64_tr_b16 v[116:117], v15 offset:0
  ds_read_b64_tr_b16 v[118:119], v15 offset:512
  s_cmp_eq_u32 s51, 1
  s_cbranch_scc1 L_ohave_8
  s_mov_b32 s47, 0
k2_kernel_poll3:
  buffer_load_dword v12, v11, s[8:11], s50 offen sc1
  s_waitcnt vmcnt(0)
  v_cmp_eq_u32 vcc, 1, v12
  s_add_u32 s47, s47, 1
  s_nop 0
  s_cmp_eq_u64 vcc, -1
  s_cbranch_scc1 k2_kernel_poll3d
  s_cmp_ge_u32 s47, 0x4000
  s_cbranch_scc1 k2_kernel_poll3d
  s_branch k2_kernel_poll3
k2_kernel_poll3d:
  s_lshl_b32 s39, s12, 1
  s_add_u32 s39, s39, s49
  s_lshl_b32 s39, s39, 5
  s_lshl_b32 s47, s48, 4
  s_add_u32 s39, s39, s47
  s_lshl_b32 s39, s39, 10
  s_add_u32 s39, s39, 18350080
  s_add_u32 s36, s39, 0
  buffer_load_dwordx4 v[80:83], v13, s[8:11], s36 offen sc1
  s_add_u32 s36, s39, 1024
  buffer_load_dwordx4 v[84:87], v13, s[8:11], s36 offen sc1
  s_add_u32 s36, s39, 2048
  buffer_load_dwordx4 v[88:91], v13, s[8:11], s36 offen sc1
  s_add_u32 s36, s39, 3072
  buffer_load_dwordx4 v[92:95], v13, s[8:11], s36 offen sc1
  s_add_u32 s36, s39, 4096
  buffer_load_dwordx4 v[96:99], v13, s[8:11], s36 offen sc1
  s_add_u32 s36, s39, 5120
  buffer_load_dwordx4 v[100:103], v13, s[8:11], s36 offen sc1
  s_add_u32 s36, s39, 6144
  buffer_load_dwordx4 v[104:107], v13, s[8:11], s36 offen sc1
  s_add_u32 s36, s39, 7168
  buffer_load_dwordx4 v[108:111], v13, s[8:11], s36 offen sc1
L_ohave_8:
  ds_read_b64_tr_b16 v[120:121], v14 offset:2048
  ds_read_b64_tr_b16 v[122:123], v14 offset:2560
  ds_read_b64_tr_b16 v[124:125], v15 offset:2048
  ds_read_b64_tr_b16 v[126:127], v15 offset:2560
  s_waitcnt vmcnt(7) lgkmcnt(4)
  v_mfma_f32_32x32x16_bf16 v[48:63], v[112:115], v[80:83], 0
  v_mfma_f32_32x32x16_bf16 v[64:79], v[116:119], v[80:83], 0
  s_add_u32 s36, s39, 8192
  buffer_load_dwordx4 v[80:83], v13, s[8:11], s36 offen sc1
  ds_read_b64_tr_b16 v[112:113], v14 offset:4096
  ds_read_b64_tr_b16 v[114:115], v14 offset:4608
  ds_read_b64_tr_b16 v[116:117], v15 offset:4096
  ds_read_b64_tr_b16 v[118:119], v15 offset:4608
  s_waitcnt vmcnt(7) lgkmcnt(4)
  v_mfma_f32_32x32x16_bf16 v[48:63], v[120:123], v[84:87], v[48:63]
  v_mfma_f32_32x32x16_bf16 v[64:79], v[124:127], v[84:87], v[64:79]
  s_add_u32 s36, s39, 9216
  buffer_load_dwordx4 v[84:87], v13, s[8:11], s36 offen sc1
  ds_read_b64_tr_b16 v[120:121], v14 offset:6144
  ds_read_b64_tr_b16 v[122:123], v14 offset:6656
  ds_read_b64_tr_b16 v[124:125], v15 offset:6144
  ds_read_b64_tr_b16 v[126:127], v15 offset:6656
  s_waitcnt vmcnt(7) lgkmcnt(4)
  v_mfma_f32_32x32x16_bf16 v[48:63], v[112:115], v[88:91], v[48:63]
  v_mfma_f32_32x32x16_bf16 v[64:79], v[116:119], v[88:91], v[64:79]
  s_add_u32 s36, s39, 10240
  buffer_load_dwordx4 v[88:91], v13, s[8:11], s36 offen sc1
  ds_read_b64_tr_b16 v[112:113], v14 offset:8192
  ds_read_b64_tr_b16 v[114:115], v14 offset:8704
  ds_read_b64_tr_b16 v[116:117], v15 offset:8192
  ds_read_b64_tr_b16 v[118:119], v15 offset:8704
  s_waitcnt vmcnt(7) lgkmcnt(4)
  v_mfma_f32_32x32x16_bf16 v[48:63], v[120:123], v[92:95], v[48:63]
  v_mfma_f32_32x32x16_bf16 v[64:79], v[124:127], v[92:95], v[64:79]
  s_add_u32 s36, s39, 11264
  buffer_load_dwordx4 v[92:95], v13, s[8:11], s36 offen sc1
  ds_read_b64_tr_b16 v[120:121], v14 offset:10240
  ds_read_b64_tr_b16 v[122:123], v14 offset:10752
  ds_read_b64_tr_b16 v[124:125], v15 offset:10240
  ds_read_b64_tr_b16 v[126:127], v15 offset:10752
  s_waitcnt vmcnt(7) lgkmcnt(4)
  v_mfma_f32_32x32x16_bf16 v[48:63], v[112:115], v[96:99], v[48:63]
  v_mfma_f32_32x32x16_bf16 v[64:79], v[116:119], v[96:99], v[64:79]
  s_add_u32 s36, s39, 12288
  buffer_load_dwordx4 v[96:99], v13, s[8:11], s36 offen sc1
  ds_read_b64_tr_b16 v[112:113], v14 offset:12288
  ds_read_b64_tr_b16 v[114:115], v14 offset:12800
  ds_read_b64_tr_b16 v[116:117], v15 offset:12288
  ds_read_b64_tr_b16 v[118:119], v15 offset:12800
  s_waitcnt vmcnt(7) lgkmcnt(4)
  v_mfma_f32_32x32x16_bf16 v[48:63], v[120:123], v[100:103], v[48:63]
  v_mfma_f32_32x32x16_bf16 v[64:79], v[124:127], v[100:103], v[64:79]
  s_add_u32 s36, s39, 13312
  buffer_load_dwordx4 v[100:103], v13, s[8:11], s36 offen sc1
  ds_read_b64_tr_b16 v[120:121], v14 offset:14336
  ds_read_b64_tr_b16 v[122:123], v14 offset:14848
  ds_read_b64_tr_b16 v[124:125], v15 offset:14336
  ds_read_b64_tr_b16 v[126:127], v15 offset:14848
  s_waitcnt vmcnt(7) lgkmcnt(4)
  v_mfma_f32_32x32x16_bf16 v[48:63], v[112:115], v[104:107], v[48:63]
  v_mfma_f32_32x32x16_bf16 v[64:79], v[116:119], v[104:107], v[64:79]
  s_add_u32 s36, s39, 14336
  buffer_load_dwordx4 v[104:107], v13, s[8:11], s36 offen sc1
  ds_read_b64_tr_b16 v[112:113], v14 offset:16384
  ds_read_b64_tr_b16 v[114:115], v14 offset:16896
  ds_read_b64_tr_b16 v[116:117], v15 offset:16384
  ds_read_b64_tr_b16 v[118:119], v15 offset:16896
  s_waitcnt vmcnt(7) lgkmcnt(4)
  v_mfma_f32_32x32x16_bf16 v[48:63], v[120:123], v[108:111], v[48:63]
  v_mfma_f32_32x32x16_bf16 v[64:79], v[124:127], v[108:111], v[64:79]
  s_add_u32 s36, s39, 15360
  buffer_load_dwordx4 v[108:111], v13, s[8:11], s36 offen sc1
  ds_read_b64_tr_b16 v[120:121], v14 offset:18432
  ds_read_b64_tr_b16 v[122:123], v14 offset:18944
  ds_read_b64_tr_b16 v[124:125], v15 offset:18432
  ds_read_b64_tr_b16 v[126:127], v15 offset:18944
  s_waitcnt vmcnt(7) lgkmcnt(4)
  v_mfma_f32_32x32x16_bf16 v[48:63], v[112:115], v[80:83], v[48:63]
  v_mfma_f32_32x32x16_bf16 v[64:79], v[116:119], v[80:83], v[64:79]
  ds_read_b64_tr_b16 v[112:113], v14 offset:20480
  ds_read_b64_tr_b16 v[114:115], v14 offset:20992
  ds_read_b64_tr_b16 v[116:117], v15 offset:20480
  ds_read_b64_tr_b16 v[118:119], v15 offset:20992
  s_waitcnt vmcnt(6) lgkmcnt(4)
  v_mfma_f32_32x32x16_bf16 v[48:63], v[120:123], v[84:87], v[48:63]
  v_mfma_f32_32x32x16_bf16 v[64:79], v[124:127], v[84:87], v[64:79]
  ds_read_b64_tr_b16 v[120:121], v14 offset:22528
  ds_read_b64_tr_b16 v[122:123], v14 offset:23040
  ds_read_b64_tr_b16 v[124:125], v15 offset:22528
  ds_read_b64_tr_b16 v[126:127], v15 offset:23040
  s_waitcnt vmcnt(5) lgkmcnt(4)
  v_mfma_f32_32x32x16_bf16 v[48:63], v[112:115], v[88:91], v[48:63]
  v_mfma_f32_32x32x16_bf16 v[64:79], v[116:119], v[88:91], v[64:79]
  ds_read_b64_tr_b16 v[112:113], v14 offset:24576
  ds_read_b64_tr_b16 v[114:115], v14 offset:25088
  ds_read_b64_tr_b16 v[116:117], v15 offset:24576
  ds_read_b64_tr_b16 v[118:119], v15 offset:25088
  s_waitcnt vmcnt(4) lgkmcnt(4)
  v_mfma_f32_32x32x16_bf16 v[48:63], v[120:123], v[92:95], v[48:63]
  v_mfma_f32_32x32x16_bf16 v[64:79], v[124:127], v[92:95], v[64:79]
  ds_read_b64_tr_b16 v[120:121], v14 offset:26624
  ds_read_b64_tr_b16 v[122:123], v14 offset:27136
  ds_read_b64_tr_b16 v[124:125], v15 offset:26624
  ds_read_b64_tr_b16 v[126:127], v15 offset:27136
  s_waitcnt vmcnt(3) lgkmcnt(4)
  v_mfma_f32_32x32x16_bf16 v[48:63], v[112:115], v[96:99], v[48:63]
  v_mfma_f32_32x32x16_bf16 v[64:79], v[116:119], v[96:99], v[64:79]
  ds_read_b64_tr_b16 v[112:113], v14 offset:28672
  ds_read_b64_tr_b16 v[114:115], v14 offset:29184
  ds_read_b64_tr_b16 v[116:117], v15 offset:28672
  ds_read_b64_tr_b16 v[118:119], v15 offset:29184
  s_waitcnt vmcnt(2) lgkmcnt(4)
  v_mfma_f32_32x32x16_bf16 v[48:63], v[120:123], v[100:103], v[48:63]
  v_mfma_f32_32x32x16_bf16 v[64:79], v[124:127], v[100:103], v[64:79]
  ds_read_b64_tr_b16 v[120:121], v14 offset:30720
  ds_read_b64_tr_b16 v[122:123], v14 offset:31232
  ds_read_b64_tr_b16 v[124:125], v15 offset:30720
  ds_read_b64_tr_b16 v[126:127], v15 offset:31232
  s_waitcnt vmcnt(1) lgkmcnt(4)
  v_mfma_f32_32x32x16_bf16 v[48:63], v[112:115], v[104:107], v[48:63]
  v_mfma_f32_32x32x16_bf16 v[64:79], v[116:119], v[104:107], v[64:79]
  s_waitcnt vmcnt(0) lgkmcnt(0)
  v_mfma_f32_32x32x16_bf16 v[48:63], v[120:123], v[108:111], v[48:63]
  v_mfma_f32_32x32x16_bf16 v[64:79], v[124:127], v[108:111], v[64:79]
  s_nop 11
  v_add_u32 v4, s31, v13
  ds_write_b128 v4, v[64:67] offset:0
  ds_write_b128 v4, v[68:71] offset:1024
  ds_write_b128 v4, v[72:75] offset:2048
  ds_write_b128 v4, v[76:79] offset:3072
  s_waitcnt lgkmcnt(0)
  s_lshl_b32 s42, s49, 2
  s_add_u32 s42, s42, 159768
  v_mov_b32 v2, s42
  v_mov_b32 v3, 1
  s_mov_b64 s[40:41], exec
  s_mov_b64 exec, 1
  ds_add_u32 v2, v3
  s_mov_b64 exec, s[40:41]
  s_mov_b32 s42, 0
L_k2_kernel_pb_9:
  ds_read_b32 v3, v2
  s_waitcnt lgkmcnt(0)
  v_readfirstlane_b32 s43, v3
  s_add_u32 s42, s42, 1
  s_cmp_ge_u32 s43, 2
  s_cbranch_scc1 L_k2_kernel_pbd_10
  s_cmp_lt_u32 s42, 0x20000
  s_cbranch_scc1 L_k2_kernel_pb_9
L_k2_kernel_pbd_10:
  s_xor_b32 s46, s30, 2
  s_mul_i32 s46, s46, 6144
  s_add_u32 s46, s46, 135168
  v_add_u32 v4, s46, v13
  ds_read_b128 v[64:67], v4 offset:0
  ds_read_b128 v[68:71], v4 offset:1024
  ds_read_b128 v[72:75], v4 offset:2048
  ds_read_b128 v[76:79], v4 offset:3072
  s_waitcnt lgkmcnt(0)
  v_add_f32 v48, v48, v64
  v_add_f32 v49, v49, v65
  v_add_f32 v50, v50, v66
  v_add_f32 v51, v51, v67
  v_add_f32 v52, v52, v68
  v_add_f32 v53, v53, v69
  v_add_f32 v54, v54, v70
  v_add_f32 v55, v55, v71
  v_add_f32 v56, v56, v72
  v_add_f32 v57, v57, v73
  v_add_f32 v58, v58, v74
  v_add_f32 v59, v59, v75
  v_add_f32 v60, v60, v76
  v_add_f32 v61, v61, v77
  v_add_f32 v62, v62, v78
  v_add_f32 v63, v63, v79
  v_mul_f32 v48, v48, v16
  v_mul_f32 v49, v49, v17
  v_mul_f32 v50, v50, v18
  v_mul_f32 v51, v51, v19
  v_mul_f32 v52, v52, v20
  v_mul_f32 v53, v53, v21
  v_mul_f32 v54, v54, v22
  v_mul_f32 v55, v55, v23
  v_mul_f32 v56, v56, v24
  v_mul_f32 v57, v57, v25
  v_mul_f32 v58, v58, v26
  v_mul_f32 v59, v59, v27
  v_mul_f32 v60, v60, v28
  v_mul_f32 v61, v61, v29
  v_mul_f32 v62, v62, v30
  v_mul_f32 v63, v63, v31
  ds_write_b128 v8, v[48:51] offset:0
  ds_write_b128 v8, v[52:55] offset:32
  ds_write_b128 v8, v[56:59] offset:64
  ds_write_b128 v8, v[60:63] offset:96
  ds_read_b128 v[64:67], v10 offset:0
  ds_read_b128 v[68:71], v10 offset:16
  ds_read_b128 v[72:75], v10 offset:2304
  ds_read_b128 v[76:79], v10 offset:2320
  s_mov_b32 s56, s84
  s_mov_b32 s57, s85
  s_mov_b32 s58, 2097152
  s_mov_b32 s59, 0x20000
  s_waitcnt lgkmcnt(2)
  v_add_f32 v64, v64, v32
  v_add_f32 v65, v65, v33
  v_add_f32 v66, v66, v34
  v_add_f32 v67, v67, v35
  v_add_f32 v68, v68, v36
  v_add_f32 v69, v69, v37
  v_add_f32 v70, v70, v38
  v_add_f32 v71, v71, v39
  v_cvt_pk_bf16_f32 v48, v64, v65
  v_cvt_pk_bf16_f32 v49, v66, v67
  v_cvt_pk_bf16_f32 v50, v68, v69
  v_cvt_pk_bf16_f32 v51, v70, v71
  buffer_store_dwordx4 v[48:51], v0, s[56:59], s44 offen sc1
  s_waitcnt lgkmcnt(0)
  v_add_f32 v72, v72, v40
  v_add_f32 v73, v73, v41
  v_add_f32 v74, v74, v42
  v_add_f32 v75, v75, v43
  v_add_f32 v76, v76, v44
  v_add_f32 v77, v77, v45
  v_add_f32 v78, v78, v46
  v_add_f32 v79, v79, v47
  v_cvt_pk_bf16_f32 v52, v72, v73
  v_cvt_pk_bf16_f32 v53, v74, v75
  v_cvt_pk_bf16_f32 v54, v76, v77
  v_cvt_pk_bf16_f32 v55, v78, v79
  buffer_store_dwordx4 v[52:55], v0, s[56:59], s45 offen sc1
  s_endpgm
k2_kernel_attn:
  s_lshl_b32 s15, s13, 3
  s_add_u32 s15, s15, s14
  v_lshlrev_b32 v84, 4, v1
  s_lshl_b32 s20, s12, 16
  s_lshl_b32 s21, s15, 10
  s_add_u32 s20, s20, s21
  buffer_load_dwordx4 v[4:7], v84, s[8:11], s20 offen
  v_add_u32 v80, 0, v84
  v_and_b32 v85, 31, v1
  v_lshrrev_b32 v86, 5, v1
  v_mul_u32_u24 v86, 272, v86
  v_lshl_add_u32 v85, v85, 4, v86
  v_add_u32 v81, 65536, v85
  v_mov_b32 v106, v80
  v_mov_b32 v107, v81
  v_and_b32 v89, 31, v1
  v_cmp_le_u32 vcc, 17, v89
  v_mov_b32 v90, 159808
  v_mov_b32 v91, 4352
  v_mov_b32 v92, 0
  v_cndmask_b32 v123, v81, v90, vcc
  v_add_u32 v81, 544, v81
  v_cndmask_b32 v81, v81, v90, vcc
  v_cndmask_b32 v124, v91, v92, vcc
  s_cmp_lg_u32 s14, 0
  s_cbranch_scc1 L_zf_11
  v_lshlrev_b32 v93, 4, v1
  v_add_u32 v93, 159744, v93
  v_mov_b32 v96, 0
  v_mov_b32 v97, 0
  v_mov_b32 v98, 0
  v_mov_b32 v99, 0
  ds_write_b128 v93, v[96:99] offset:0
  ds_write_b128 v93, v[96:99] offset:1024
  ds_write_b128 v93, v[96:99] offset:2048
  ds_write_b128 v93, v[96:99] offset:3072
  s_waitcnt lgkmcnt(0)
L_zf_11:
  v_mov_b32 v64, 0
  v_mov_b32 v65, 0
  v_mov_b32 v66, 0
  v_mov_b32 v67, 0
  v_mov_b32 v68, 0
  v_mov_b32 v69, 0
  v_mov_b32 v70, 0
  v_mov_b32 v71, 0
  v_mov_b32 v72, 0
  v_mov_b32 v73, 0
  v_mov_b32 v74, 0
  v_mov_b32 v75, 0
  v_mov_b32 v76, 0
  v_mov_b32 v77, 0
  v_mov_b32 v78, 0
  v_mov_b32 v79, 0
  s_waitcnt vmcnt(0)
  s_barrier
  ds_read_b128 v[8:11], v80
  ds_read_b128 v[12:15], v123
  s_waitcnt lgkmcnt(1)
  v_mfma_f32_32x32x16_bf16 v[32:47], v[8:11], v[4:7], 0
  ds_read_b128 v[8:11], v80 offset:1024
  s_nop 11
  s_cmp_ge_u32 s14, 4
  s_cbranch_scc1 L_pr_12
  s_setprio 2
  s_branch L_pr_13
L_pr_12:
  s_setprio 1
L_pr_13:
  s_waitcnt lgkmcnt(0)
  v_mfma_f32_32x32x16_bf16 v[48:63], v[8:11], v[4:7], 0
  ds_read_b128 v[8:11], v80 offset:2048
  ds_read_b128 v[28:31], v81 offset:544
  v_exp_f32 v32, v32
  v_exp_f32 v33, v33
  v_exp_f32 v34, v34
  v_cvt_pk_bf16_f32 v20, v32, v33
  v_exp_f32 v35, v35
  v_exp_f32 v36, v36
  v_cvt_pk_bf16_f32 v21, v34, v35
  v_exp_f32 v37, v37
  ds_read_b128 v[16:19], v81 offset:0
  v_exp_f32 v38, v38
  v_exp_f32 v39, v39
  v_cvt_pk_bf16_f32 v22, v36, v37
  v_exp_f32 v40, v40
  v_cvt_pk_bf16_f32 v23, v38, v39
  v_exp_f32 v41, v41
  v_exp_f32 v42, v42
  v_mfma_f32_32x32x16_bf16 v[64:79], v[12:15], v[20:23], v[64:79]
  v_cvt_pk_bf16_f32 v24, v40, v41
  v_exp_f32 v43, v43
  v_exp_f32 v44, v44
  v_cvt_pk_bf16_f32 v25, v42, v43
  v_exp_f32 v45, v45
  v_exp_f32 v46, v46
  v_exp_f32 v47, v47
  v_cvt_pk_bf16_f32 v26, v44, v45
  v_cvt_pk_bf16_f32 v27, v46, v47
  s_waitcnt lgkmcnt(0)
  v_mfma_f32_32x32x16_bf16 v[32:47], v[8:11], v[4:7], 0
  ds_read_b128 v[8:11], v80 offset:3072
  ds_read_b128 v[12:15], v81 offset:1632
  v_exp_f32 v48, v48
  v_exp_f32 v49, v49
  v_exp_f32 v50, v50
  v_cvt_pk_bf16_f32 v20, v48, v49
  v_exp_f32 v51, v51
  v_exp_f32 v52, v52
  v_cvt_pk_bf16_f32 v21, v50, v51
  v_exp_f32 v53, v53
  v_mfma_f32_32x32x16_bf16 v[64:79], v[16:19], v[24:27], v[64:79]
  ds_read_b128 v[16:19], v81 offset:1088
  v_exp_f32 v54, v54
  v_exp_f32 v55, v55
  v_cvt_pk_bf16_f32 v22, v52, v53
  v_exp_f32 v56, v56
  v_cvt_pk_bf16_f32 v23, v54, v55
  v_exp_f32 v57, v57
  v_exp_f32 v58, v58
  v_mfma_f32_32x32x16_bf16 v[64:79], v[28:31], v[20:23], v[64:79]
  v_cvt_pk_bf16_f32 v24, v56, v57
  v_exp_f32 v59, v59
  v_exp_f32 v60, v60
  v_cvt_pk_bf16_f32 v25, v58, v59
  v_exp_f32 v61, v61
  v_exp_f32 v62, v62
  v_exp_f32 v63, v63
  v_cvt_pk_bf16_f32 v26, v60, v61
  v_cvt_pk_bf16_f32 v27, v62, v63
  s_waitcnt lgkmcnt(0)
  v_mfma_f32_32x32x16_bf16 v[48:63], v[8:11], v[4:7], 0
  ds_read_b128 v[8:11], v80 offset:4096
  ds_read_b128 v[28:31], v81 offset:2720
  v_exp_f32 v32, v32
  v_exp_f32 v33, v33
  v_exp_f32 v34, v34
  v_cvt_pk_bf16_f32 v20, v32, v33
  v_exp_f32 v35, v35
  v_exp_f32 v36, v36
  v_cvt_pk_bf16_f32 v21, v34, v35
  v_exp_f32 v37, v37
  v_mfma_f32_32x32x16_bf16 v[64:79], v[16:19], v[24:27], v[64:79]
  ds_read_b128 v[16:19], v81 offset:2176
  v_exp_f32 v38, v38
  v_exp_f32 v39, v39
  v_cvt_pk_bf16_f32 v22, v36, v37
  v_exp_f32 v40, v40
  v_cvt_pk_bf16_f32 v23, v38, v39
  v_exp_f32 v41, v41
  v_exp_f32 v42, v42
  v_mfma_f32_32x32x16_bf16 v[64:79], v[12:15], v[20:23], v[64:79]
  v_cvt_pk_bf16_f32 v24, v40, v41
  v_exp_f32 v43, v43
  v_exp_f32 v44, v44
  v_cvt_pk_bf16_f32 v25, v42, v43
  v_exp_f32 v45, v45
  v_exp_f32 v46, v46
  v_exp_f32 v47, v47
  v_cvt_pk_bf16_f32 v26, v44, v45
  v_cvt_pk_bf16_f32 v27, v46, v47
  s_waitcnt lgkmcnt(0)
  v_mfma_f32_32x32x16_bf16 v[32:47], v[8:11], v[4:7], 0
  ds_read_b128 v[8:11], v80 offset:5120
  ds_read_b128 v[12:15], v81 offset:3808
  v_exp_f32 v48, v48
  v_exp_f32 v49, v49
  v_exp_f32 v50, v50
  v_cvt_pk_bf16_f32 v20, v48, v49
  v_exp_f32 v51, v51
  v_exp_f32 v52, v52
  v_cvt_pk_bf16_f32 v21, v50, v51
  v_exp_f32 v53, v53
  v_mfma_f32_32x32x16_bf16 v[64:79], v[16:19], v[24:27], v[64:79]
  ds_read_b128 v[16:19], v81 offset:3264
  v_exp_f32 v54, v54
  v_exp_f32 v55, v55
  v_cvt_pk_bf16_f32 v22, v52, v53
  v_exp_f32 v56, v56
  v_cvt_pk_bf16_f32 v23, v54, v55
  v_exp_f32 v57, v57
  v_exp_f32 v58, v58
  v_mfma_f32_32x32x16_bf16 v[64:79], v[28:31], v[20:23], v[64:79]
  v_cvt_pk_bf16_f32 v24, v56, v57
  v_exp_f32 v59, v59
  v_exp_f32 v60, v60
  v_cvt_pk_bf16_f32 v25, v58, v59
  v_exp_f32 v61, v61
  v_exp_f32 v62, v62
  v_exp_f32 v63, v63
  v_cvt_pk_bf16_f32 v26, v60, v61
  v_cvt_pk_bf16_f32 v27, v62, v63
  v_add_u32 v81, v124, v81
  s_waitcnt lgkmcnt(0)
  v_mfma_f32_32x32x16_bf16 v[48:63], v[8:11], v[4:7], 0
  ds_read_b128 v[8:11], v80 offset:6144
  ds_read_b128 v[28:31], v81 offset:544
  v_exp_f32 v32, v32
  v_exp_f32 v33, v33
  v_exp_f32 v34, v34
  v_cvt_pk_bf16_f32 v20, v32, v33
  v_exp_f32 v35, v35
  v_exp_f32 v36, v36
  v_cvt_pk_bf16_f32 v21, v34, v35
  v_exp_f32 v37, v37
  v_mfma_f32_32x32x16_bf16 v[64:79], v[16:19], v[24:27], v[64:79]
  ds_read_b128 v[16:19], v81 offset:0
  v_exp_f32 v38, v38
  v_exp_f32 v39, v39
  v_cvt_pk_bf16_f32 v22, v36, v37
  v_exp_f32 v40, v40
  v_cvt_pk_bf16_f32 v23, v38, v39
  v_exp_f32 v41, v41
  v_exp_f32 v42, v42
  v_mfma_f32_32x32x16_bf16 v[64:79], v[12:15], v[20:23], v[64:79]
  v_cvt_pk_bf16_f32 v24, v40, v41
  v_exp_f32 v43, v43
  v_exp_f32 v44, v44
  v_cvt_pk_bf16_f32 v25, v42, v43
  v_exp_f32 v45, v45
  v_exp_f32 v46, v46
  v_exp_f32 v47, v47
  v_cvt_pk_bf16_f32 v26, v44, v45
  v_cvt_pk_bf16_f32 v27, v46, v47
  s_waitcnt lgkmcnt(0)
  v_mfma_f32_32x32x16_bf16 v[32:47], v[8:11], v[4:7], 0
  ds_read_b128 v[8:11], v80 offset:7168
  ds_read_b128 v[12:15], v81 offset:1632
  v_exp_f32 v48, v48
  v_exp_f32 v49, v49
  v_exp_f32 v50, v50
  v_cvt_pk_bf16_f32 v20, v48, v49
  v_exp_f32 v51, v51
  v_exp_f32 v52, v52
  v_cvt_pk_bf16_f32 v21, v50, v51
  v_exp_f32 v53, v53
  v_mfma_f32_32x32x16_bf16 v[64:79], v[16:19], v[24:27], v[64:79]
  ds_read_b128 v[16:19], v81 offset:1088
  v_exp_f32 v54, v54
  v_exp_f32 v55, v55
  v_cvt_pk_bf16_f32 v22, v52, v53
  v_exp_f32 v56, v56
  v_cvt_pk_bf16_f32 v23, v54, v55
  v_exp_f32 v57, v57
  v_exp_f32 v58, v58
  v_mfma_f32_32x32x16_bf16 v[64:79], v[28:31], v[20:23], v[64:79]
  v_cvt_pk_bf16_f32 v24, v56, v57
  v_exp_f32 v59, v59
  v_exp_f32 v60, v60
  v_cvt_pk_bf16_f32 v25, v58, v59
  v_exp_f32 v61, v61
  v_exp_f32 v62, v62
  v_exp_f32 v63, v63
  v_cvt_pk_bf16_f32 v26, v60, v61
  v_cvt_pk_bf16_f32 v27, v62, v63
  v_mov_b32 v87, 159748
  s_mov_b32 s22, 0
L_kvw_14:
  ds_read_b32 v88, v87
  s_waitcnt lgkmcnt(0)
  v_readfirstlane_b32 s21, v88
  s_add_u32 s22, s22, 1
  s_cmp_ge_u32 s21, 4
  s_cbranch_scc1 L_kvd_15
  s_cmp_lt_u32 s22, 0x40000
  s_cbranch_scc1 L_kvw_14
L_kvd_15:
  s_waitcnt lgkmcnt(0)
  v_mfma_f32_32x32x16_bf16 v[48:63], v[8:11], v[4:7], 0
  ds_read_b128 v[8:11], v80 offset:8192
  ds_read_b128 v[28:31], v81 offset:2720
  v_exp_f32 v32, v32
  v_exp_f32 v33, v33
  v_exp_f32 v34, v34
  v_cvt_pk_bf16_f32 v20, v32, v33
  v_exp_f32 v35, v35
  v_exp_f32 v36, v36
  v_cvt_pk_bf16_f32 v21, v34, v35
  v_exp_f32 v37, v37
  v_mfma_f32_32x32x16_bf16 v[64:79], v[16:19], v[24:27], v[64:79]
  ds_read_b128 v[16:19], v81 offset:2176
  v_exp_f32 v38, v38
  v_exp_f32 v39, v39
  v_cvt_pk_bf16_f32 v22, v36, v37
  v_exp_f32 v40, v40
  v_cvt_pk_bf16_f32 v23, v38, v39
  v_exp_f32 v41, v41
  v_exp_f32 v42, v42
  v_mfma_f32_32x32x16_bf16 v[64:79], v[12:15], v[20:23], v[64:79]
  v_cvt_pk_bf16_f32 v24, v40, v41
  v_exp_f32 v43, v43
  v_exp_f32 v44, v44
  v_cvt_pk_bf16_f32 v25, v42, v43
  v_exp_f32 v45, v45
  v_exp_f32 v46, v46
  v_exp_f32 v47, v47
  v_cvt_pk_bf16_f32 v26, v44, v45
  v_cvt_pk_bf16_f32 v27, v46, v47
  s_waitcnt lgkmcnt(0)
  v_mfma_f32_32x32x16_bf16 v[32:47], v[8:11], v[4:7], 0
  ds_read_b128 v[8:11], v80 offset:9216
  ds_read_b128 v[12:15], v81 offset:3808
  v_exp_f32 v48, v48
  v_exp_f32 v49, v49
  v_exp_f32 v50, v50
  v_cvt_pk_bf16_f32 v20, v48, v49
  v_exp_f32 v51, v51
  v_exp_f32 v52, v52
  v_cvt_pk_bf16_f32 v21, v50, v51
  v_exp_f32 v53, v53
  v_mfma_f32_32x32x16_bf16 v[64:79], v[16:19], v[24:27], v[64:79]
  ds_read_b128 v[16:19], v81 offset:3264
  v_exp_f32 v54, v54
  v_exp_f32 v55, v55
  v_cvt_pk_bf16_f32 v22, v52, v53
  v_exp_f32 v56, v56
  v_cvt_pk_bf16_f32 v23, v54, v55
  v_exp_f32 v57, v57
  v_exp_f32 v58, v58
  v_mfma_f32_32x32x16_bf16 v[64:79], v[28:31], v[20:23], v[64:79]
  v_cvt_pk_bf16_f32 v24, v56, v57
  v_exp_f32 v59, v59
  v_exp_f32 v60, v60
  v_cvt_pk_bf16_f32 v25, v58, v59
  v_exp_f32 v61, v61
  v_exp_f32 v62, v62
  v_exp_f32 v63, v63
  v_cvt_pk_bf16_f32 v26, v60, v61
  v_cvt_pk_bf16_f32 v27, v62, v63
  v_add_u32 v81, v124, v81
  v_add_u32 v80, 8192, v80
  s_mov_b32 s16, 1
k2_kernel_loop:
  s_cmp_lg_u32 s16, 6
  s_cbranch_scc1 L_pd_16
  s_cmp_ge_u32 s14, 4
  s_cbranch_scc1 L_pr_17
  s_setprio 0
  s_branch L_pr_18
L_pr_17:
  s_setprio 1
L_pr_18:
L_pd_16:
  s_cmp_lg_u32 s16, 3
  s_cbranch_scc1 L_pg_19
  v_mov_b32 v87, 159752
  v_mov_b32 v88, 1
  s_mov_b64 s[20:21], exec
  s_mov_b64 exec, 1
  ds_add_u32 v87, v88
  s_mov_b64 exec, s[20:21]
L_pg_19:
  s_waitcnt lgkmcnt(0)
  v_mfma_f32_32x32x16_bf16 v[48:63], v[8:11], v[4:7], 0
  ds_read_b128 v[8:11], v80 offset:2048
  ds_read_b128 v[28:31], v81 offset:544
  v_exp_f32 v32, v32
  v_exp_f32 v33, v33
  v_exp_f32 v34, v34
  v_cvt_pk_bf16_f32 v20, v32, v33
  v_exp_f32 v35, v35
  v_exp_f32 v36, v36
  v_cvt_pk_bf16_f32 v21, v34, v35
  v_exp_f32 v37, v37
  v_mfma_f32_32x32x16_bf16 v[64:79], v[16:19], v[24:27], v[64:79]
  ds_read_b128 v[16:19], v81 offset:0
  v_exp_f32 v38, v38
  v_exp_f32 v39, v39
  v_cvt_pk_bf16_f32 v22, v36, v37
  v_exp_f32 v40, v40
  v_cvt_pk_bf16_f32 v23, v38, v39
  v_exp_f32 v41, v41
  v_exp_f32 v42, v42
  v_mfma_f32_32x32x16_bf16 v[64:79], v[12:15], v[20:23], v[64:79]
  v_cvt_pk_bf16_f32 v24, v40, v41
  v_exp_f32 v43, v43
  v_exp_f32 v44, v44
  v_cvt_pk_bf16_f32 v25, v42, v43
  v_exp_f32 v45, v45
  v_exp_f32 v46, v46
  v_exp_f32 v47, v47
  v_cvt_pk_bf16_f32 v26, v44, v45
  v_cvt_pk_bf16_f32 v27, v46, v47
  s_waitcnt lgkmcnt(0)
  v_mfma_f32_32x32x16_bf16 v[32:47], v[8:11], v[4:7], 0
  ds_read_b128 v[8:11], v80 offset:3072
  ds_read_b128 v[12:15], v81 offset:1632
  v_exp_f32 v48, v48
  v_exp_f32 v49, v49
  v_exp_f32 v50, v50
  v_cvt_pk_bf16_f32 v20, v48, v49
  v_exp_f32 v51, v51
  v_exp_f32 v52, v52
  v_cvt_pk_bf16_f32 v21, v50, v51
  v_exp_f32 v53, v53
  v_mfma_f32_32x32x16_bf16 v[64:79], v[16:19], v[24:27], v[64:79]
  ds_read_b128 v[16:19], v81 offset:1088
  v_exp_f32 v54, v54
  v_exp_f32 v55, v55
  v_cvt_pk_bf16_f32 v22, v52, v53
  v_exp_f32 v56, v56
  v_cvt_pk_bf16_f32 v23, v54, v55
  v_exp_f32 v57, v57
  v_exp_f32 v58, v58
  v_mfma_f32_32x32x16_bf16 v[64:79], v[28:31], v[20:23], v[64:79]
  v_cvt_pk_bf16_f32 v24, v56, v57
  v_exp_f32 v59, v59
  v_exp_f32 v60, v60
  v_cvt_pk_bf16_f32 v25, v58, v59
  v_exp_f32 v61, v61
  v_exp_f32 v62, v62
  v_exp_f32 v63, v63
  v_cvt_pk_bf16_f32 v26, v60, v61
  v_cvt_pk_bf16_f32 v27, v62, v63
  s_waitcnt lgkmcnt(0)
  v_mfma_f32_32x32x16_bf16 v[48:63], v[8:11], v[4:7], 0
  ds_read_b128 v[8:11], v80 offset:4096
  ds_read_b128 v[28:31], v81 offset:2720
  v_exp_f32 v32, v32
  v_exp_f32 v33, v33
  v_exp_f32 v34, v34
  v_cvt_pk_bf16_f32 v20, v32, v33
  v_exp_f32 v35, v35
  v_exp_f32 v36, v36
  v_cvt_pk_bf16_f32 v21, v34, v35
  v_exp_f32 v37, v37
  v_mfma_f32_32x32x16_bf16 v[64:79], v[16:19], v[24:27], v[64:79]
  ds_read_b128 v[16:19], v81 offset:2176
  v_exp_f32 v38, v38
  v_exp_f32 v39, v39
  v_cvt_pk_bf16_f32 v22, v36, v37
  v_exp_f32 v40, v40
  v_cvt_pk_bf16_f32 v23, v38, v39
  v_exp_f32 v41, v41
  v_exp_f32 v42, v42
  v_mfma_f32_32x32x16_bf16 v[64:79], v[12:15], v[20:23], v[64:79]
  v_cvt_pk_bf16_f32 v24, v40, v41
  v_exp_f32 v43, v43
  v_exp_f32 v44, v44
  v_cvt_pk_bf16_f32 v25, v42, v43
  v_exp_f32 v45, v45
  v_exp_f32 v46, v46
  v_exp_f32 v47, v47
  v_cvt_pk_bf16_f32 v26, v44, v45
  v_cvt_pk_bf16_f32 v27, v46, v47
  s_waitcnt lgkmcnt(0)
  v_mfma_f32_32x32x16_bf16 v[32:47], v[8:11], v[4:7], 0
  ds_read_b128 v[8:11], v80 offset:5120
  ds_read_b128 v[12:15], v81 offset:3808
  v_exp_f32 v48, v48
  v_exp_f32 v49, v49
  v_exp_f32 v50, v50
  v_cvt_pk_bf16_f32 v20, v48, v49
  v_exp_f32 v51, v51
  v_exp_f32 v52, v52
  v_cvt_pk_bf16_f32 v21, v50, v51
  v_exp_f32 v53, v53
  v_mfma_f32_32x32x16_bf16 v[64:79], v[16:19], v[24:27], v[64:79]
  ds_read_b128 v[16:19], v81 offset:3264
  v_exp_f32 v54, v54
  v_exp_f32 v55, v55
  v_cvt_pk_bf16_f32 v22, v52, v53
  v_exp_f32 v56, v56
  v_cvt_pk_bf16_f32 v23, v54, v55
  v_exp_f32 v57, v57
  v_exp_f32 v58, v58
  v_mfma_f32_32x32x16_bf16 v[64:79], v[28:31], v[20:23], v[64:79]
  v_cvt_pk_bf16_f32 v24, v56, v57
  v_exp_f32 v59, v59
  v_exp_f32 v60, v60
  v_cvt_pk_bf16_f32 v25, v58, v59
  v_exp_f32 v61, v61
  v_exp_f32 v62, v62
  v_exp_f32 v63, v63
  v_cvt_pk_bf16_f32 v26, v60, v61
  v_cvt_pk_bf16_f32 v27, v62, v63
  v_add_u32 v81, v124, v81
  s_waitcnt lgkmcnt(0)
  v_mfma_f32_32x32x16_bf16 v[48:63], v[8:11], v[4:7], 0
  ds_read_b128 v[8:11], v80 offset:6144
  ds_read_b128 v[28:31], v81 offset:544
  v_exp_f32 v32, v32
  v_exp_f32 v33, v33
  v_exp_f32 v34, v34
  v_cvt_pk_bf16_f32 v20, v32, v33
  v_exp_f32 v35, v35
  v_exp_f32 v36, v36
  v_cvt_pk_bf16_f32 v21, v34, v35
  v_exp_f32 v37, v37
  v_mfma_f32_32x32x16_bf16 v[64:79], v[16:19], v[24:27], v[64:79]
  ds_read_b128 v[16:19], v81 offset:0
  v_exp_f32 v38, v38
  v_exp_f32 v39, v39
  v_cvt_pk_bf16_f32 v22, v36, v37
  v_exp_f32 v40, v40
  v_cvt_pk_bf16_f32 v23, v38, v39
  v_exp_f32 v41, v41
  v_exp_f32 v42, v42
  v_mfma_f32_32x32x16_bf16 v[64:79], v[12:15], v[20:23], v[64:79]
  v_cvt_pk_bf16_f32 v24, v40, v41
  v_exp_f32 v43, v43
  v_exp_f32 v44, v44
  v_cvt_pk_bf16_f32 v25, v42, v43
  v_exp_f32 v45, v45
  v_exp_f32 v46, v46
  v_exp_f32 v47, v47
  v_cvt_pk_bf16_f32 v26, v44, v45
  v_cvt_pk_bf16_f32 v27, v46, v47
  s_waitcnt lgkmcnt(0)
  v_mfma_f32_32x32x16_bf16 v[32:47], v[8:11], v[4:7], 0
  ds_read_b128 v[8:11], v80 offset:7168
  ds_read_b128 v[12:15], v81 offset:1632
  v_exp_f32 v48, v48
  v_exp_f32 v49, v49
  v_exp_f32 v50, v50
  v_cvt_pk_bf16_f32 v20, v48, v49
  v_exp_f32 v51, v51
  v_exp_f32 v52, v52
  v_cvt_pk_bf16_f32 v21, v50, v51
  v_exp_f32 v53, v53
  v_mfma_f32_32x32x16_bf16 v[64:79], v[16:19], v[24:27], v[64:79]
  ds_read_b128 v[16:19], v81 offset:1088
  v_exp_f32 v54, v54
  v_exp_f32 v55, v55
  v_cvt_pk_bf16_f32 v22, v52, v53
  v_exp_f32 v56, v56
  v_cvt_pk_bf16_f32 v23, v54, v55
  v_exp_f32 v57, v57
  v_exp_f32 v58, v58
  v_mfma_f32_32x32x16_bf16 v[64:79], v[28:31], v[20:23], v[64:79]
  v_cvt_pk_bf16_f32 v24, v56, v57
  v_exp_f32 v59, v59
  v_exp_f32 v60, v60
  v_cvt_pk_bf16_f32 v25, v58, v59
  v_exp_f32 v61, v61
  v_exp_f32 v62, v62
  v_exp_f32 v63, v63
  v_cvt_pk_bf16_f32 v26, v60, v61
  v_cvt_pk_bf16_f32 v27, v62, v63
  s_cmp_lg_u32 s16, 3
  s_cbranch_scc1 L_kv2s_20
  v_mov_b32 v87, 159756
  s_mov_b32 s22, 0
L_kvw_21:
  ds_read_b32 v88, v87
  s_waitcnt lgkmcnt(0)
  v_readfirstlane_b32 s21, v88
  s_add_u32 s22, s22, 1
  s_cmp_ge_u32 s21, 4
  s_cbranch_scc1 L_kvd_22
  s_cmp_lt_u32 s22, 0x40000
  s_cbranch_scc1 L_kvw_21
L_kvd_22:
L_kv2s_20:
  s_waitcnt lgkmcnt(0)
  v_mfma_f32_32x32x16_bf16 v[48:63], v[8:11], v[4:7], 0
  ds_read_b128 v[8:11], v80 offset:8192
  ds_read_b128 v[28:31], v81 offset:2720
  v_exp_f32 v32, v32
  v_exp_f32 v33, v33
  v_exp_f32 v34, v34
  v_cvt_pk_bf16_f32 v20, v32, v33
  v_exp_f32 v35, v35
  v_exp_f32 v36, v36
  v_cvt_pk_bf16_f32 v21, v34, v35
  v_exp_f32 v37, v37
  v_mfma_f32_32x32x16_bf16 v[64:79], v[16:19], v[24:27], v[64:79]
  ds_read_b128 v[16:19], v81 offset:2176
  v_exp_f32 v38, v38
  v_exp_f32 v39, v39
  v_cvt_pk_bf16_f32 v22, v36, v37
  v_exp_f32 v40, v40
  v_cvt_pk_bf16_f32 v23, v38, v39
  v_exp_f32 v41, v41
  v_exp_f32 v42, v42
  v_mfma_f32_32x32x16_bf16 v[64:79], v[12:15], v[20:23], v[64:79]
  v_cvt_pk_bf16_f32 v24, v40, v41
  v_exp_f32 v43, v43
  v_exp_f32 v44, v44
  v_cvt_pk_bf16_f32 v25, v42, v43
  v_exp_f32 v45, v45
  v_exp_f32 v46, v46
  v_exp_f32 v47, v47
  v_cvt_pk_bf16_f32 v26, v44, v45
  v_cvt_pk_bf16_f32 v27, v46, v47
  s_waitcnt lgkmcnt(0)
  v_mfma_f32_32x32x16_bf16 v[32:47], v[8:11], v[4:7], 0
  ds_read_b128 v[8:11], v80 offset:9216
  ds_read_b128 v[12:15], v81 offset:3808
  v_exp_f32 v48, v48
  v_exp_f32 v49, v49
  v_exp_f32 v50, v50
  v_cvt_pk_bf16_f32 v20, v48, v49
  v_exp_f32 v51, v51
  v_exp_f32 v52, v52
  v_cvt_pk_bf16_f32 v21, v50, v51
  v_exp_f32 v53, v53
  v_mfma_f32_32x32x16_bf16 v[64:79], v[16:19], v[24:27], v[64:79]
  ds_read_b128 v[16:19], v81 offset:3264
  v_exp_f32 v54, v54
  v_exp_f32 v55, v55
  v_cvt_pk_bf16_f32 v22, v52, v53
  v_exp_f32 v56, v56
  v_cvt_pk_bf16_f32 v23, v54, v55
  v_exp_f32 v57, v57
  v_exp_f32 v58, v58
  v_mfma_f32_32x32x16_bf16 v[64:79], v[28:31], v[20:23], v[64:79]
  v_cvt_pk_bf16_f32 v24, v56, v57
  v_exp_f32 v59, v59
  v_exp_f32 v60, v60
  v_cvt_pk_bf16_f32 v25, v58, v59
  v_exp_f32 v61, v61
  v_exp_f32 v62, v62
  v_exp_f32 v63, v63
  v_cvt_pk_bf16_f32 v26, v60, v61
  v_cvt_pk_bf16_f32 v27, v62, v63
  v_add_u32 v81, v124, v81
  v_add_u32 v80, 8192, v80
  s_add_u32 s16, s16, 1
  s_cmp_lt_u32 s16, 7
  s_cbranch_scc1 k2_kernel_loop
  v_mov_b32 v87, 159760
  v_mov_b32 v88, 1
  s_mov_b64 s[20:21], exec
  s_mov_b64 exec, 1
  ds_add_u32 v87, v88
  s_mov_b64 exec, s[20:21]
  s_waitcnt lgkmcnt(0)
  v_mfma_f32_32x32x16_bf16 v[48:63], v[8:11], v[4:7], 0
  ds_read_b128 v[8:11], v80 offset:2048
  ds_read_b128 v[28:31], v81 offset:544
  v_exp_f32 v32, v32
  v_exp_f32 v33, v33
  v_exp_f32 v34, v34
  v_cvt_pk_bf16_f32 v20, v32, v33
  v_exp_f32 v35, v35
  v_exp_f32 v36, v36
  v_cvt_pk_bf16_f32 v21, v34, v35
  v_exp_f32 v37, v37
  v_mfma_f32_32x32x16_bf16 v[64:79], v[16:19], v[24:27], v[64:79]
  ds_read_b128 v[16:19], v81 offset:0
  v_exp_f32 v38, v38
  v_exp_f32 v39, v39
  v_cvt_pk_bf16_f32 v22, v36, v37
  v_exp_f32 v40, v40
  v_cvt_pk_bf16_f32 v23, v38, v39
  v_exp_f32 v41, v41
  v_exp_f32 v42, v42
  v_mfma_f32_32x32x16_bf16 v[64:79], v[12:15], v[20:23], v[64:79]
  v_cvt_pk_bf16_f32 v24, v40, v41
  v_exp_f32 v43, v43
  v_exp_f32 v44, v44
  v_cvt_pk_bf16_f32 v25, v42, v43
  v_exp_f32 v45, v45
  v_exp_f32 v46, v46
  v_exp_f32 v47, v47
  v_cvt_pk_bf16_f32 v26, v44, v45
  v_cvt_pk_bf16_f32 v27, v46, v47
  s_waitcnt lgkmcnt(0)
  v_mfma_f32_32x32x16_bf16 v[32:47], v[8:11], v[4:7], 0
  ds_read_b128 v[8:11], v80 offset:3072
  ds_read_b128 v[12:15], v81 offset:1632
  v_exp_f32 v48, v48
  v_exp_f32 v49, v49
  v_exp_f32 v50, v50
  v_cvt_pk_bf16_f32 v20, v48, v49
  v_exp_f32 v51, v51
  v_exp_f32 v52, v52
  v_cvt_pk_bf16_f32 v21, v50, v51
  v_exp_f32 v53, v53
  v_mfma_f32_32x32x16_bf16 v[64:79], v[16:19], v[24:27], v[64:79]
  ds_read_b128 v[16:19], v81 offset:1088
  v_exp_f32 v54, v54
  v_exp_f32 v55, v55
  v_cvt_pk_bf16_f32 v22, v52, v53
  v_exp_f32 v56, v56
  v_cvt_pk_bf16_f32 v23, v54, v55
  v_exp_f32 v57, v57
  v_exp_f32 v58, v58
  v_mfma_f32_32x32x16_bf16 v[64:79], v[28:31], v[20:23], v[64:79]
  v_cvt_pk_bf16_f32 v24, v56, v57
  v_exp_f32 v59, v59
  v_exp_f32 v60, v60
  v_cvt_pk_bf16_f32 v25, v58, v59
  v_exp_f32 v61, v61
  v_exp_f32 v62, v62
  v_exp_f32 v63, v63
  v_cvt_pk_bf16_f32 v26, v60, v61
  v_cvt_pk_bf16_f32 v27, v62, v63
  s_waitcnt lgkmcnt(0)
  v_mfma_f32_32x32x16_bf16 v[48:63], v[8:11], v[4:7], 0
  ds_read_b128 v[8:11], v80 offset:4096
  ds_read_b128 v[28:31], v81 offset:2720
  v_exp_f32 v32, v32
  v_exp_f32 v33, v33
  v_exp_f32 v34, v34
  v_cvt_pk_bf16_f32 v20, v32, v33
  v_exp_f32 v35, v35
  v_exp_f32 v36, v36
  v_cvt_pk_bf16_f32 v21, v34, v35
  v_exp_f32 v37, v37
  v_mfma_f32_32x32x16_bf16 v[64:79], v[16:19], v[24:27], v[64:79]
  ds_read_b128 v[16:19], v81 offset:2176
  v_exp_f32 v38, v38
  v_exp_f32 v39, v39
  v_cvt_pk_bf16_f32 v22, v36, v37
  v_exp_f32 v40, v40
  v_cvt_pk_bf16_f32 v23, v38, v39
  v_exp_f32 v41, v41
  v_exp_f32 v42, v42
  v_mfma_f32_32x32x16_bf16 v[64:79], v[12:15], v[20:23], v[64:79]
  v_cvt_pk_bf16_f32 v24, v40, v41
  v_exp_f32 v43, v43
  v_exp_f32 v44, v44
  v_cvt_pk_bf16_f32 v25, v42, v43
  v_exp_f32 v45, v45
  v_exp_f32 v46, v46
  v_exp_f32 v47, v47
  v_cvt_pk_bf16_f32 v26, v44, v45
  v_cvt_pk_bf16_f32 v27, v46, v47
  s_waitcnt lgkmcnt(0)
  v_mfma_f32_32x32x16_bf16 v[32:47], v[8:11], v[4:7], 0
  ds_read_b128 v[8:11], v80 offset:5120
  ds_read_b128 v[12:15], v81 offset:3808
  v_exp_f32 v48, v48
  v_exp_f32 v49, v49
  v_exp_f32 v50, v50
  v_cvt_pk_bf16_f32 v20, v48, v49
  v_exp_f32 v51, v51
  v_exp_f32 v52, v52
  v_cvt_pk_bf16_f32 v21, v50, v51
  v_exp_f32 v53, v53
  v_mfma_f32_32x32x16_bf16 v[64:79], v[16:19], v[24:27], v[64:79]
  ds_read_b128 v[16:19], v81 offset:3264
  v_exp_f32 v54, v54
  v_exp_f32 v55, v55
  v_cvt_pk_bf16_f32 v22, v52, v53
  v_exp_f32 v56, v56
  v_cvt_pk_bf16_f32 v23, v54, v55
  v_exp_f32 v57, v57
  v_exp_f32 v58, v58
  v_mfma_f32_32x32x16_bf16 v[64:79], v[28:31], v[20:23], v[64:79]
  v_cvt_pk_bf16_f32 v24, v56, v57
  v_exp_f32 v59, v59
  v_exp_f32 v60, v60
  v_cvt_pk_bf16_f32 v25, v58, v59
  v_exp_f32 v61, v61
  v_exp_f32 v62, v62
  v_exp_f32 v63, v63
  v_cvt_pk_bf16_f32 v26, v60, v61
  v_cvt_pk_bf16_f32 v27, v62, v63
  v_add_u32 v81, v124, v81
  s_waitcnt lgkmcnt(0)
  v_mfma_f32_32x32x16_bf16 v[48:63], v[8:11], v[4:7], 0
  ds_read_b128 v[8:11], v80 offset:6144
  ds_read_b128 v[28:31], v81 offset:544
  v_exp_f32 v32, v32
  v_exp_f32 v33, v33
  v_exp_f32 v34, v34
  v_cvt_pk_bf16_f32 v20, v32, v33
  v_exp_f32 v35, v35
  v_exp_f32 v36, v36
  v_cvt_pk_bf16_f32 v21, v34, v35
  v_exp_f32 v37, v37
  v_mfma_f32_32x32x16_bf16 v[64:79], v[16:19], v[24:27], v[64:79]
  ds_read_b128 v[16:19], v81 offset:0
  v_exp_f32 v38, v38
  v_exp_f32 v39, v39
  v_cvt_pk_bf16_f32 v22, v36, v37
  v_exp_f32 v40, v40
  v_cvt_pk_bf16_f32 v23, v38, v39
  v_exp_f32 v41, v41
  v_exp_f32 v42, v42
  v_mfma_f32_32x32x16_bf16 v[64:79], v[12:15], v[20:23], v[64:79]
  v_cvt_pk_bf16_f32 v24, v40, v41
  v_exp_f32 v43, v43
  v_exp_f32 v44, v44
  v_cvt_pk_bf16_f32 v25, v42, v43
  v_exp_f32 v45, v45
  v_exp_f32 v46, v46
  v_exp_f32 v47, v47
  v_cvt_pk_bf16_f32 v26, v44, v45
  v_cvt_pk_bf16_f32 v27, v46, v47
  s_waitcnt lgkmcnt(0)
  v_mfma_f32_32x32x16_bf16 v[32:47], v[8:11], v[4:7], 0
  ds_read_b128 v[8:11], v80 offset:7168
  ds_read_b128 v[12:15], v81 offset:1632
  v_exp_f32 v48, v48
  v_exp_f32 v49, v49
  v_exp_f32 v50, v50
  v_cvt_pk_bf16_f32 v20, v48, v49
  v_exp_f32 v51, v51
  v_exp_f32 v52, v52
  v_cvt_pk_bf16_f32 v21, v50, v51
  v_exp_f32 v53, v53
  v_mfma_f32_32x32x16_bf16 v[64:79], v[16:19], v[24:27], v[64:79]
  ds_read_b128 v[16:19], v81 offset:1088
  v_exp_f32 v54, v54
  v_exp_f32 v55, v55
  v_cvt_pk_bf16_f32 v22, v52, v53
  v_exp_f32 v56, v56
  v_cvt_pk_bf16_f32 v23, v54, v55
  v_exp_f32 v57, v57
  v_exp_f32 v58, v58
  v_mfma_f32_32x32x16_bf16 v[64:79], v[28:31], v[20:23], v[64:79]
  v_cvt_pk_bf16_f32 v24, v56, v57
  v_exp_f32 v59, v59
  v_exp_f32 v60, v60
  v_cvt_pk_bf16_f32 v25, v58, v59
  v_exp_f32 v61, v61
  v_exp_f32 v62, v62
  v_exp_f32 v63, v63
  v_cvt_pk_bf16_f32 v26, v60, v61
  v_cvt_pk_bf16_f32 v27, v62, v63
  s_waitcnt lgkmcnt(0)
  v_mfma_f32_32x32x16_bf16 v[48:63], v[8:11], v[4:7], 0
  ds_read_b128 v[28:31], v81 offset:2720
  v_exp_f32 v32, v32
  v_exp_f32 v33, v33
  v_exp_f32 v34, v34
  v_cvt_pk_bf16_f32 v20, v32, v33
  v_exp_f32 v35, v35
  v_exp_f32 v36, v36
  v_cvt_pk_bf16_f32 v21, v34, v35
  v_exp_f32 v37, v37
  v_mfma_f32_32x32x16_bf16 v[64:79], v[16:19], v[24:27], v[64:79]
  ds_read_b128 v[16:19], v81 offset:2176
  v_exp_f32 v38, v38
  v_exp_f32 v39, v39
  v_cvt_pk_bf16_f32 v22, v36, v37
  v_exp_f32 v40, v40
  v_cvt_pk_bf16_f32 v23, v38, v39
  v_exp_f32 v41, v41
  v_exp_f32 v42, v42
  v_mfma_f32_32x32x16_bf16 v[64:79], v[12:15], v[20:23], v[64:79]
  v_cvt_pk_bf16_f32 v24, v40, v41
  v_exp_f32 v43, v43
  v_exp_f32 v44, v44
  v_cvt_pk_bf16_f32 v25, v42, v43
  v_exp_f32 v45, v45
  v_exp_f32 v46, v46
  v_exp_f32 v47, v47
  v_cvt_pk_bf16_f32 v26, v44, v45
  v_cvt_pk_bf16_f32 v27, v46, v47
  s_waitcnt lgkmcnt(0)
  v_exp_f32 v48, v48
  v_exp_f32 v49, v49
  v_exp_f32 v50, v50
  v_cvt_pk_bf16_f32 v20, v48, v49
  v_exp_f32 v51, v51
  v_exp_f32 v52, v52
  v_cvt_pk_bf16_f32 v21, v50, v51
  v_exp_f32 v53, v53
  v_mfma_f32_32x32x16_bf16 v[64:79], v[16:19], v[24:27], v[64:79]
  ds_read_b128 v[16:19], v81 offset:3264
  v_exp_f32 v54, v54
  v_exp_f32 v55, v55
  v_cvt_pk_bf16_f32 v22, v52, v53
  v_exp_f32 v56, v56
  v_cvt_pk_bf16_f32 v23, v54, v55
  v_exp_f32 v57, v57
  v_exp_f32 v58, v58
  v_mfma_f32_32x32x16_bf16 v[64:79], v[28:31], v[20:23], v[64:79]
  v_cvt_pk_bf16_f32 v24, v56, v57
  v_exp_f32 v59, v59
  v_exp_f32 v60, v60
  v_cvt_pk_bf16_f32 v25, v58, v59
  v_exp_f32 v61, v61
  v_exp_f32 v62, v62
  v_exp_f32 v63, v63
  v_cvt_pk_bf16_f32 v26, v60, v61
  v_cvt_pk_bf16_f32 v27, v62, v63
  v_add_u32 v81, v124, v81
  s_nop 0
  s_waitcnt lgkmcnt(0)
  s_nop 0
  v_mfma_f32_32x32x16_bf16 v[64:79], v[16:19], v[24:27], v[64:79]
  s_nop 11
  v_mov_b32 v84, v72
  v_mov_b32 v85, v72
  s_nop 1
  v_permlane32_swap_b32 v84, v85
  v_max3_f32 v86, |v64|, |v65|, |v66|
  v_max3_f32 v86, v86, |v67|, |v68|
  v_max3_f32 v86, v86, |v69|, |v70|
  v_max_f32 v86, v86, |v71|
  v_add_f32 v87, v64, v65
  v_add_f32 v87, v87, v66
  v_add_f32 v87, v87, v67
  v_add_f32 v87, v87, v68
  v_add_f32 v87, v87, v69
  v_add_f32 v87, v87, v70
  v_add_f32 v87, v87, v71
  v_mov_b32 v88, 0x21800000
  v_mov_b32 v89, 0x5d800000
  v_cmp_ge_f32 s[20:21], v84, v88
  v_cmp_le_f32 s[22:23], v84, v89
  v_mov_b32 v89, 0x7b800000
  v_cmp_le_f32 s[24:25], v86, v89
  v_cmp_o_f32 s[26:27], v87, v87
  s_nop 0
  s_and_b64 s[20:21], s[20:21], s[22:23]
  s_and_b64 s[24:25], s[24:25], s[26:27]
  s_and_b64 s[20:21], s[20:21], s[24:25]
  s_cmp_eq_u64 s[20:21], -1
  s_cbranch_scc1 k2_kernel_fin
  v_mov_b32 v84, 0xff800000
  v_mov_b32 v64, 0
  v_mov_b32 v65, 0
  v_mov_b32 v66, 0
  v_mov_b32 v67, 0
  v_mov_b32 v68, 0
  v_mov_b32 v69, 0
  v_mov_b32 v70, 0
  v_mov_b32 v71, 0
  v_mov_b32 v72, 0
  v_mov_b32 v73, 0
  v_mov_b32 v74, 0
  v_mov_b32 v75, 0
  v_mov_b32 v76, 0
  v_mov_b32 v77, 0
  v_mov_b32 v78, 0
  v_mov_b32 v79, 0
  v_subrev_u32 v104, 0, v106
  v_subrev_u32 v105, 65536, v107
  s_lshl_b32 s28, s12, 16
  s_add_u32 s28, s28, 2097152
  s_mul_i32 s29, s12, 69632
  s_add_u32 s29, s29, 4194304
  s_mov_b32 s16, 0
k2_kernel_slow:
  buffer_load_dwordx4 v[8:11], v104, s[8:11], s28 offen sc1
  buffer_load_dwordx4 v[12:15], v105, s[8:11], s29 offen sc1
  buffer_load_dwordx4 v[16:19], v105, s[8:11], s29 offen offset:544 sc1
  s_waitcnt vmcnt(0)
  v_mfma_f32_32x32x16_bf16 v[32:47], v[8:11], v[4:7], 0
  s_nop 13
  v_max3_f32 v86, v32, v33, v34
  v_max3_f32 v86, v86, v35, v36
  v_max3_f32 v86, v86, v37, v38
  v_max3_f32 v86, v86, v39, v40
  v_max3_f32 v86, v86, v41, v42
  v_max3_f32 v86, v86, v43, v44
  v_max3_f32 v86, v86, v45, v46
  v_max_f32 v86, v86, v47
  v_mov_b32 v87, v86
  s_nop 1
  v_permlane32_swap_b32 v86, v87
  v_max3_f32 v86, v86, v87, v84
  v_sub_f32 v87, v84, v86
  v_cmp_eq_f32 vcc, v84, v86
  v_exp_f32 v87, v87
  v_mov_b32 v88, 1.0
  v_cndmask_b32 v87, v87, v88, vcc
  v_mov_b32 v84, v86
  v_mul_f32 v64, v64, v87
  v_mul_f32 v65, v65, v87
  v_mul_f32 v66, v66, v87
  v_mul_f32 v67, v67, v87
  v_mul_f32 v68, v68, v87
  v_mul_f32 v69, v69, v87
  v_mul_f32 v70, v70, v87
  v_mul_f32 v71, v71, v87
  v_mul_f32 v72, v72, v87
  v_mul_f32 v73, v73, v87
  v_mul_f32 v74, v74, v87
  v_mul_f32 v75, v75, v87
  v_mul_f32 v76, v76, v87
  v_mul_f32 v77, v77, v87
  v_mul_f32 v78, v78, v87
  v_mul_f32 v79, v79, v87
  v_sub_f32 v32, v32, v84
  v_sub_f32 v33, v33, v84
  v_sub_f32 v34, v34, v84
  v_sub_f32 v35, v35, v84
  v_sub_f32 v36, v36, v84
  v_sub_f32 v37, v37, v84
  v_sub_f32 v38, v38, v84
  v_sub_f32 v39, v39, v84
  v_sub_f32 v40, v40, v84
  v_sub_f32 v41, v41, v84
  v_sub_f32 v42, v42, v84
  v_sub_f32 v43, v43, v84
  v_sub_f32 v44, v44, v84
  v_sub_f32 v45, v45, v84
  v_sub_f32 v46, v46, v84
  v_sub_f32 v47, v47, v84
  v_exp_f32 v32, v32
  v_exp_f32 v33, v33
  v_exp_f32 v34, v34
  v_exp_f32 v35, v35
  v_exp_f32 v36, v36
  v_exp_f32 v37, v37
  v_exp_f32 v38, v38
  v_exp_f32 v39, v39
  v_exp_f32 v40, v40
  v_exp_f32 v41, v41
  v_exp_f32 v42, v42
  v_exp_f32 v43, v43
  v_exp_f32 v44, v44
  v_exp_f32 v45, v45
  v_exp_f32 v46, v46
  v_exp_f32 v47, v47
  s_nop 0
  v_cvt_pk_bf16_f32 v20, v32, v33
  v_cvt_pk_bf16_f32 v21, v34, v35
  v_cvt_pk_bf16_f32 v22, v36, v37
  v_cvt_pk_bf16_f32 v23, v38, v39
  v_cvt_pk_bf16_f32 v24, v40, v41
  v_cvt_pk_bf16_f32 v25, v42, v43
  v_cvt_pk_bf16_f32 v26, v44, v45
  v_cvt_pk_bf16_f32 v27, v46, v47
  s_nop 1
  v_mfma_f32_32x32x16_bf16 v[64:79], v[12:15], v[20:23], v[64:79]
  v_mfma_f32_32x32x16_bf16 v[64:79], v[16:19], v[24:27], v[64:79]
  s_add_u32 s28, s28, 1024
  s_add_u32 s29, s29, 1088
  s_nop 13
  s_add_u32 s16, s16, 1
  s_cmp_lt_u32 s16, 64
  s_cbranch_scc1 k2_kernel_slow
  v_mov_b32 v84, v72
  v_mov_b32 v85, v72
  s_nop 1
  v_permlane32_swap_b32 v84, v85
k2_kernel_fin:
  v_rcp_f32 v84, v84
  s_nop 0
  v_mul_f32 v64, v64, v84
  v_mul_f32 v65, v65, v84
  v_mul_f32 v66, v66, v84
  v_mul_f32 v67, v67, v84
  v_mul_f32 v68, v68, v84
  v_mul_f32 v69, v69, v84
  v_mul_f32 v70, v70, v84
  v_mul_f32 v71, v71, v84
  v_cvt_pk_bf16_f32 v20, v64, v65
  v_cvt_pk_bf16_f32 v21, v66, v67
  v_cvt_pk_bf16_f32 v22, v68, v69
  v_cvt_pk_bf16_f32 v23, v70, v71
  s_lshl_b32 s20, s15, 5
  s_add_u32 s20, s20, s12
  s_lshl_b32 s20, s20, 10
  s_add_u32 s20, s20, 18350080
  v_lshlrev_b32 v85, 4, v1
  buffer_store_dwordx4 v[20:23], v85, s[8:11], s20 offen sc1
  s_waitcnt vmcnt(0)
  s_lshr_b32 s21, s15, 3
  s_bfe_u32 s22, s15, 0x20001
  s_lshl_b32 s22, s22, 3
  s_add_u32 s21, s21, s22
  s_lshl_b32 s21, s21, 11
  s_and_b32 s22, s15, 1
  s_lshl_b32 s22, s22, 5
  s_add_u32 s22, s22, s12
  s_lshl_b32 s22, s22, 2
  s_add_u32 s21, s21, s22
  s_add_u32 s21, s21, 20972672
  v_mov_b32 v84, 1
  v_lshlrev_b32 v85, 16, v1
  s_mov_b64 exec, 0xff
  buffer_store_dword v84, v85, s[8:11], s21 offen sc1
  s_mov_b64 exec, -1
k2_kernel_exit:
  s_endpgm
code_end:
  s_endpgm
.section .rodata,"a"
.p2align 6
.amdhsa_kernel k1_kernel
  .amdhsa_next_free_vgpr 128
  .amdhsa_next_free_sgpr 96
  .amdhsa_accum_offset 128
  .amdhsa_group_segment_fixed_size 0
  .amdhsa_kernarg_size 88
  .amdhsa_user_sgpr_count 2
  .amdhsa_user_sgpr_kernarg_segment_ptr 1
  .amdhsa_system_sgpr_workgroup_id_x 1
.end_amdhsa_kernel
.text
.section .rodata,"a"
.p2align 6
.amdhsa_kernel k2_kernel
  .amdhsa_next_free_vgpr 128
  .amdhsa_next_free_sgpr 96
  .amdhsa_accum_offset 128
  .amdhsa_group_segment_fixed_size 0
  .amdhsa_kernarg_size 88
  .amdhsa_user_sgpr_count 2
  .amdhsa_user_sgpr_kernarg_segment_ptr 1
  .amdhsa_system_sgpr_workgroup_id_x 1
.end_amdhsa_kernel
.text
```
